```python
import torch

def _softmax(x, axis=-1):
    return torch.softmax(x, dim=axis)
def _gelu(x):
    return torch.nn.functional.gelu(x, approximate="tanh")
def _silu(x):
    return torch.nn.functional.silu(x)
def _sigmoid(x):
    return torch.sigmoid(x)
def _layernorm(x, axis=-1, eps=1e-5):
    m = x.mean(dim=axis, keepdim=True)
    v = x.var(dim=axis, keepdim=True, unbiased=False)
    return (x - m) / torch.sqrt(v + eps)
def _scatter_add(tgt, idx, src, axis=0):
    return tgt.clone().index_add_(axis, idx, src)
def _segment_sum(src, seg, n):
    out = torch.zeros((n,) + src.shape[1:], dtype=src.dtype)
    return out.index_add_(0, seg, src)
def _pad(x, pw):
    flat = tuple(v for pair in reversed(pw) for v in pair)
    return torch.nn.functional.pad(x, flat)

kernel_name = 'sequential_preLN__ssm_conv_s4d__mixer_channel_mlp__prompt'

def setup_inputs():

    _w = (lambda a: (lambda t: t.to(torch.bfloat16) if t.is_floating_point() else t)(torch.as_tensor(a)))
    def _A_setup():
        Bsz, L, D, N = 1, 2048, 512, 128
        return {
            "u": _w((lambda *s: torch.randn(*s, dtype=torch.bfloat16) * 0.05)(Bsz, L, D)),
            "log_A_real": _w((lambda *s: torch.randn(*s, dtype=torch.bfloat16) * 3.2)(D, N) * 0.5),
            "A_imag": _w((lambda *s: torch.randn(*s, dtype=torch.bfloat16) * 0.05)(D, N) * 3.14),
            "C_real": _w((lambda *s: torch.randn(*s, dtype=torch.bfloat16) * 0.1)(D, N) / N ** 0.5),
            "C_imag": _w((lambda *s: torch.randn(*s, dtype=torch.bfloat16) * 0.1)(D, N) / N ** 0.5),
            "log_dt": _w((lambda *s: torch.randn(*s, dtype=torch.bfloat16) * 0.05)(D) * 0.5 - 4.0),
            "D_skip": _w((lambda *s: torch.randn(*s, dtype=torch.bfloat16) * 0.05)(D)),
        }
    _A_in = _A_setup()

    def _B_setup():
        B, S, D, F = 1, 2048, 512, 1792
        return {
            "x": _w((lambda *s: torch.randn(*s, dtype=torch.bfloat16) * 0.05)(B, S, D)),
            "w1": _w((lambda *s: torch.randn(*s, dtype=torch.bfloat16) * 1.6)(D, F) * (D ** -0.5)),
            "b1": _w((lambda *s: torch.randn(*s, dtype=torch.bfloat16) * 0.8)(F)),
            "w2": _w((lambda *s: torch.randn(*s, dtype=torch.bfloat16) * 0.05)(F, D) * (F ** -0.5)),
            "b2": _w((lambda *s: torch.randn(*s, dtype=torch.bfloat16) * 0.05)(D)),
        }
    _B_in = _B_setup()

    return {
        "A_u": _A_in["u"],
        "A_log_A_real": _A_in["log_A_real"],
        "A_A_imag": _A_in["A_imag"],
        "A_C_real": _A_in["C_real"],
        "A_C_imag": _A_in["C_imag"],
        "A_log_dt": _A_in["log_dt"],
        "A_D_skip": _A_in["D_skip"],
        "B_x": _B_in["x"],
        "B_w1": _B_in["w1"],
        "B_b1": _B_in["b1"],
        "B_w2": _B_in["w2"],
        "B_b2": _B_in["b2"],
    }

def reference(A_u, A_log_A_real, A_A_imag, A_C_real, A_C_imag, A_log_dt, A_D_skip, B_x, B_w1, B_b1, B_w2, B_b2):
    def _A_ref(u, log_A_real, A_imag, C_real, C_imag, log_dt, D_skip):
        L = u.shape[1]
        dt = torch.exp(log_dt)
        A = -torch.exp(log_A_real) + 1j * A_imag
        C = (C_real + 1j * C_imag) * dt[:, None]
        pos = (lambda x, dt: x.to(dt))(torch.arange(L), log_dt.dtype)
        P = torch.exp((A * dt[:, None])[:, :, None] * pos[None, None, :])
        K = 2.0 * torch.einsum("dn,dnl->dl", C, P).real
        L2 = 2 * L
        u_t = (lambda x, *d: x.permute(*d))(u, 0, 2, 1)
        Kf = (lambda x, *a, **k: torch.fft.rfft(x.float(), *a, **k))(K, L2)
        Uf = (lambda x, *a, **k: torch.fft.rfft(x.float(), *a, **k))(u_t, L2)
        y = (lambda x, *a, **k: torch.fft.irfft(x, *a, **k).to(torch.bfloat16))(Uf * Kf[None, :, :], L2)[:, :, :L]
        y = (lambda x, *d: x.permute(*d))(y, 0, 2, 1)
        return y + u * D_skip[None, None, :]

    def _B_ref(x, w1, b1, w2, b2):
        y = _layernorm(x, axis=-1)
        h = _gelu(torch.einsum("bsd,df->bsf", y, w1) + b1)
        return torch.einsum("bsf,fd->bsd", h, w2) + b2

    x = A_u
    h = x + _A_ref(_layernorm(x, axis=-1), A_log_A_real, A_A_imag, A_C_real, A_C_imag, A_log_dt, A_D_skip)
    h2 = h + _B_ref(_layernorm(h, axis=-1), B_w1, B_b1, B_w2, B_b2)
    return h2
```

```asm
; @launch grid=(256,1,1) block=(256,1,1) lds=163840
.amdgcn_target "amdgcn-amd-amdhsa--gfx950"
.text
.globl sequential_preLN__ssm_conv_s4d__mixer_channel_mlp__prompt_kernel
.p2align 12
.p2align 8
.type sequential_preLN__ssm_conv_s4d__mixer_channel_mlp__prompt_kernel,@function
sequential_preLN__ssm_conv_s4d__mixer_channel_mlp__prompt_kernel:
  s_cmpk_ge_u32 s2, 256
  s_cbranch_scc1 L_end
  s_load_dwordx16 s[8:23], s[0:1], 0
  s_load_dwordx2 s[36:37], s[0:1], 112
  s_load_dwordx8 s[24:31], s[0:1], 64
  s_load_dwordx2 s[32:33], s[0:1], 96
  v_lshlrev_b32 v10, 7, v0
  s_getpc_b64 s[40:41]
L_pc:
  s_lshr_b32 s7, s2, 3
  s_lshl_b32 s4, s7, 10
  s_add_u32 s42, s4, 1024
  s_min_u32 s42, s42, L_end-L_pc
  s_mov_b32 s43, 0x20000
  buffer_load_dword a113, v10, s[40:43], s4 offen
  s_and_b32 s3, s7, 24
  s_add_u32 s7, s7, s3
  s_and_b32 s3, s2, 1
  s_lshl3_add_u32 s7, s3, s7
  s_and_b32 s3, s2, 6
  v_lshrrev_b32 v13, 5, v0
  s_lshl_b32 s3, s3, 5
  v_and_b32 v14, 31, v0
  s_add_u32 s3, s3, s7
  v_lshlrev_b32 v13, 10, v13
  s_lshl_b32 s7, s3, 13
  v_lshlrev_b32 v14, 4, v14
  s_lshl_b32 s4, s3, 9
  v_add3_u32 v13, v13, v14, s7
  v_lshl_add_u32 v27, v0, 1, s4
  v_lshrrev_b32 v26, 7, v27
  v_and_b32 v26, -2, v26
  s_waitcnt lgkmcnt(0)
  global_load_ushort v48, v27, s[10:11]
  global_load_ushort v49, v27, s[12:13]
  global_load_ushort v50, v27, s[14:15]
  global_load_ushort v51, v27, s[16:17]
  global_load_ushort v81, v26, s[18:19]
  global_load_ushort v95, v26, s[20:21]
  global_load_dwordx4 v[32:35], v13, s[8:9]
  global_load_dwordx4 v[36:39], v13, s[8:9] offset:512
  v_lshrrev_b32 v14, 1, v0
  v_and_b32 v15, 1, v0
  v_lshrrev_b32 v12, 6, v0
  v_lshlrev_b32 v16, 3, v14
  v_lshlrev_b32 v15, 12, v15
  v_readfirstlane_b32 s6, v12
  v_and_b32 v1, 63, v0
  v_lshlrev_b32 v10, 7, v1
  v_add3_u32 v16, v16, v15, s7
  s_load_dwordx8 s[68:75], s[36:37], 0
  global_load_dwordx2 v[40:41], v16, s[8:9] offset:0
  global_load_dwordx2 v[42:43], v16, s[8:9] offset:1024
  global_load_dwordx2 v[44:45], v16, s[8:9] offset:2048
  global_load_dwordx2 v[46:47], v16, s[8:9] offset:3072
  s_lshl2_add_u32 s89, s2, s6
  v_min_u32 v10, 0x680, v10
  s_mul_i32 s89, s89, 1792
  s_mov_b32 s42, 1835008
  s_mov_b32 s40, s24
  s_mov_b32 s41, s25
  s_mov_b32 s44, s28
  s_mov_b32 s45, s29
  s_mov_b32 s46, s42
  s_mov_b32 s47, s43
  v_lshlrev_b32 v2, 4, v1
  v_lshl_add_u32 v3, v12, 11, v2
  v_mov_b32 v56, 0x60006000
  v_mov_b32 v57, 0x60006000
  v_mov_b32 v58, 0x60006000
  v_mov_b32 v59, 0x60006000
  s_add_u32 s82, s7, 4194304
  s_mov_b32 s38, 33554432
  s_mov_b32 s39, 0x20000
  s_and_b32 s99, s3, 3
  s_bfe_u32 s91, s3, 0x20002
  s_lshr_b32 s93, s3, 4
  v_lshrrev_b32 v18, 4, v1
  v_lshlrev_b32 v19, 2, v18
  v_and_b32 v30, 15, v1
  v_xor_b32 v19, v19, v30
  v_lshlrev_b32 v19, 4, v19
  s_lshl_b32 s5, s99, 8
  s_mul_i32 s4, s91, 896
  s_add_u32 s4, s4, s5
  s_cmp_eq_u32 s99, 3
  s_cselect_b32 s7, 112, -1
  v_mul_u32_u24 v20, 3584, v18
  v_cmp_lt_u32 vcc, s7, v19
  v_add3_u32 v20, v20, v19, s4
  v_lshl_add_u32 v4, v18, 10, v19
  v_and_b32 v19, 0x80, v19
  v_mad_u32_u24 v4, v19, 3, v4
  v_mov_b32 v30, 0x7ff00000
  v_cndmask_b32 v20, v20, v30, vcc
  v_add_u32 v21, 13312, v20
  v_add_u32 v22, 26624, v20
  v_add_u32 v23, 39936, v20
  s_and_b32 s92, s93, 0
  s_lshl2_add_u32 s7, s92, s6
  s_mul_i32 s86, s7, 229376
  s_xor_b32 s7, s7, 4
  s_mul_i32 s87, s7, 229376
  s_lshl_b32 s96, s6, 14
  s_lshr_b32 s94, s6, 1
  s_or_b32 s4, s2, s6
  s_cbranch_scc1 L_np0
  v_lshrrev_b32 v28, 3, v1
  v_mul_u32_u24 v28, 8704, v28
  v_add_u32 v28, v28, v2
  s_mov_b32 s4, 262144
  buffer_store_dwordx4 v[56:59], v28, s[36:39], s4 offen sc1
L_np0:
  v_lshrrev_b32 v29, 5, v0
  v_and_b32 v30, 16, v0
  v_cmp_ne_u32 vcc, 0, v30
  v_mov_b32 v30, 161088
  v_lshlrev_b32 v28, 3, v29
  v_add_u32 v28, 160960, v28
  v_cndmask_b32 v17, v30, v28, vcc
  v_and_b32 v28, 1, v0
  v_lshlrev_b32 v15, 5, v28
  v_add_u32 v15, 160960, v15
  v_mov_b32 v8, 0x70007000
  v_mov_b32 v52, 0
  v_mov_b32 v53, 0
  v_lshlrev_b32 v28, 4, v28
  v_lshrrev_b32 v30, 1, v0
  v_lshl_add_u32 v14, v30, 13, v28
  s_and_b32 s10, s3, 0xc0
  s_and_b32 s11, s3, 1
  s_lshl_b32 s11, s11, 5
  s_add_u32 s10, s10, s11
  s_bfe_u32 s11, s3, 0x50001
  s_add_u32 s10, s10, s11
  s_lshl_b32 s10, s10, 5
  s_add_u32 s97, s10, 4194304
  s_add_u32 s98, s10, 5242880
  s_mov_b32 s22, 0x30003000
  s_mov_b32 s90, 0
  s_mov_b32 s55, 0x3f803f80
  s_mul_i32 s4, s94, 34816
  s_add_u32 s4, s4, 65536
  v_and_b32 v29, 127, v0
  v_lshl_add_u32 v96, v29, 2, s4
  v_add_u32 v97, 544, v96
  v_add_u32 v98, 1088, v96
  v_add_u32 v99, 1632, v96
  v_add_u32 v100, 2176, v96
  v_add_u32 v101, 2720, v96
  v_add_u32 v102, 3264, v96
  v_add_u32 v103, 3808, v96
  v_and_b32 v18, 15, v1
  v_lshrrev_b32 v19, 4, v1
  v_lshl_add_u32 v28, v19, 4, s4
  v_mov_b32 v30, 544
  v_mad_u32_u24 v104, v18, v30, v28
  v_cmp_lt_u32 vcc, 7, v18
  v_and_b32 v55, 7, v18
  v_or_b32 v55, 0x0c0c0c00, v55
  s_bitcmp1_b32 s6, 0
  s_nop 0
  s_mov_b32 s7, 0x13121110
  s_cselect_b32 s4, 0x31312e2a, s7
  s_mov_b32 s7, 0x17161514
  s_cselect_b32 s10, 0x24242831, s7
  s_mov_b32 s7, 0x1b1a1918
  s_cselect_b32 s5, 0x2f2f3635, s7
  s_mov_b32 s7, 0x1f1e1d1c
  s_cselect_b32 s11, 0x2c2c302f, s7
  v_mov_b32 v54, s4
  v_mov_b32 v105, s5
  v_perm_b32 v54, s10, v54, v55
  v_perm_b32 v105, s11, v105, v55
  v_cndmask_b32 v54, v54, v105, vcc
  s_nop 0
  v_mad_u32_u24 v105, v54, v30, v28
  s_mov_b32 s7, 0x14222327
  s_cselect_b32 s4, 0x3e3e3332, s7
  s_mov_b32 s7, 0x182b2122
  s_cselect_b32 s10, 0x37373d39, s7
  s_mov_b32 s7, 0x1c26252b
  s_cselect_b32 s5, 0x34343b3a, s7
  s_mov_b32 s7, 0x29202d26
  s_cselect_b32 s11, 0x3f3f3c38, s7
  v_mov_b32 v54, s4
  v_mov_b32 v106, s5
  v_perm_b32 v54, s10, v54, v55
  v_perm_b32 v106, s11, v106, v55
  v_cndmask_b32 v54, v54, v106, vcc
  v_mad_u32_u24 v106, v54, v30, v28
  v_mov_b32 v64, 0
  v_mov_b32 v65, 0
  v_mov_b32 v66, 0
  v_mov_b32 v67, 0
  s_mul_i32 s4, s94, 4576
  s_add_u32 s4, s4, 135168
  v_add_u32 v28, s4, v2
  s_mul_i32 s4, s6, 4160
  s_add_u32 s4, s4, 144320
  v_add_u32 v29, s4, v2
  s_mov_b64 exec, 0x3fffffff
  ds_write_b128 v28, v[64:67]
  s_mov_b64 exec, 15
  ds_write_b128 v29, v[64:67] offset:4096
  s_mov_b64 exec, -1
  ds_write_b128 v29, v[64:67] offset:1024
  buffer_load_dword a113, v10, s[40:43], s89 offen
  s_and_b32 s5, s6, 1
  v_lshlrev_b32 v16, 3, v0
  s_lshl_b32 s5, s5, 8
  v_add_u32 v16, 135648, v16
  s_mul_i32 s4, s94, 4576
  v_lshlrev_b32 v28, 4, v19
  s_add_u32 s4, s4, 135424
  v_lshl_add_u32 v115, v18, 5, v28
  s_sub_u32 s4, s4, s5
  v_add_u32 v115, s4, v115
  s_mul_i32 s7, s94, 8320
  v_lshlrev_b32 v29, 1, v18
  s_add_u32 s7, s7, 144320
  v_sub_u32 v28, v28, v29
  s_sub_u32 s4, s7, s5
  v_and_b32 v29, 1, v18
  s_add_u32 s4, s4, 5472
  v_mul_u32_u24 v29, 4162, v29
  v_add_u32 v28, s4, v28
  v_sub_u32 v118, v28, v29
  v_add_u32 v116, 2048, v118
  v_add_u32 v117, 1024, v118
  s_mul_i32 s4, s5, 3
  v_add_u32 v114, s4, v115
  s_lshr_b32 s4, s5, 2
  s_add_u32 s4, s4, s7
  s_add_u32 s4, s4, 828
  v_lshlrev_b32 v28, 2, v19
  v_sub_u32 v28, v28, v18
  v_lshl_add_u32 v119, v28, 2, s4
  s_add_u32 s4, s7, 1020
  v_lshlrev_b32 v28, 2, v1
  v_sub_u32 v13, s4, v28
  v_lshlrev_b32 v29, 5, v18
  v_sub_u32 v29, s7, v29
  v_lshlrev_b32 v28, 3, v19
  v_sub_u32 v11, v29, v28
  v_mov_b32 v30, 65024
  v_lshlrev_b32 v30, v18, v30
  v_bfe_u32 v30, v30, v28, 8
  v_mul_u32_u24 v30, 0x8001, v30
  v_and_b32 v120, 65537, v30
  v_mul_u32_u24 v120, 16256, v120
  v_and_b32 v121, 262148, v30
  v_mul_u32_u24 v121, 4064, v121
  v_and_b32 v122, 1048592, v30
  v_mul_u32_u24 v122, 1016, v122
  v_and_b32 v123, 4194368, v30
  v_mul_u32_u24 v123, 254, v123
  v_mov_b32 v30, 511
  v_lshlrev_b32_e64 v30, v18, v30
  v_bfe_u32 v30, v30, v28, 8
  v_mul_u32_u24 v30, 0x8001, v30
  v_and_b32 v124, 65537, v30
  v_mul_u32_u24 v124, 16256, v124
  v_and_b32 v125, 262148, v30
  v_mul_u32_u24 v125, 4064, v125
  v_and_b32 v126, 1048592, v30
  v_mul_u32_u24 v126, 1016, v126
  v_and_b32 v127, 4194368, v30
  v_mul_u32_u24 v127, 254, v127
  v_and_b32 v28, 2, v19
  v_lshlrev_b32 v28, 8, v28
  v_and_b32 v30, 1, v19
  v_lshl_add_u32 v28, v30, 4, v28
  v_sub_u32 v12, v29, v28
  v_and_b32 v30, 3, v1
  v_and_b32 v61, 1, v19
  v_bfe_u32 v60, v1, 2, 2
  v_lshrrev_b32 v26, 5, v1
  v_xor_b32 v28, s6, v60
  v_lshlrev_b32 v28, 6, v28
  v_lshl_add_u32 v28, v60, 8, v28
  v_lshl_add_u32 v29, v30, 3, v28
  v_lshl_add_u32 v29, v61, 5, v29
  v_lshl_add_u32 v9, v26, 11, v29
  v_lshl_add_u32 v28, v26, 10, v28
  v_lshl_add_u32 v28, v61, 4, v28
  v_and_b32 v29, 1, v1
  v_lshl_add_u32 v28, v29, 5, v28
  v_bfe_u32 v29, v1, 1, 1
  v_lshl_add_u32 v28, v29, 3, v28
  s_lshl_b32 s95, s6, 13
  s_lshl_b32 s77, s6, 12
  s_lshl_b32 s4, s99, 7
  s_mul_i32 s5, s91, 458752
  s_add_u32 s4, s4, s5
  s_lshl2_add_u32 s88, s77, s4
  v_and_b32 v63, 7, v1
  v_lshrrev_b32 v62, 3, v1
  v_add_u32 v5, 3072, v4
  v_add_u32 v6, 6144, v4
  v_add_u32 v7, 9216, v4
  buffer_load_dword a113, v10, s[44:47], s89 offen
  s_mov_b64 exec, 0
  s_cmp_eq_u32 s6, 1
  s_cbranch_scc1 L_hop13
  s_cmp_eq_u32 s6, 3
  s_cbranch_scc1 L_hop29
L_wx:
  s_mov_b64 exec, -1
  s_waitcnt lgkmcnt(0)
  v_mov_b32 v80, 0x3fb8aa3b
  s_waitcnt vmcnt(8)
  v_lshlrev_b32 v81, 16, v81
  v_mul_f32 v81, v81, v80
  v_exp_f32 v81, v81
  v_lshlrev_b32 v48, 16, v48
  v_lshlrev_b32 v49, 16, v49
  v_mul_f32 v82, v48, v80
  v_exp_f32 v82, v82
  v_lshlrev_b32 v50, 16, v50
  v_lshlrev_b32 v51, 16, v51
  v_cvt_pk_bf16_f32 v81, v81, v82
  v_and_b32 v82, 0xffff0000, v81
  v_lshlrev_b32 v81, 16, v81
  v_mul_f32 v82, v82, v81
  v_mul_f32 v83, v49, v81
  v_mul_f32 v82, 0xbfb8aa3b, v82
  v_mul_f32 v83, 0.15915494, v83
  v_mul_f32 v84, 0x42000000, v81
  v_pk_mul_f32 v[176:177], v[50:51], v[84:85] op_sel_hi:[1,0]
  v_exp_f32 v86, v82
  v_fract_f32 v90, v83
  v_mul_f32 v87, 0x41800000, v82
  v_mul_f32 v91, 0x41800000, v83
  v_exp_f32 v87, v87
  v_fract_f32 v91, v91
  v_mul_f32 v88, 0x43800000, v82
  v_mul_f32 v92, 0x43800000, v83
  v_exp_f32 v88, v88
  v_fract_f32 v92, v92
  v_cos_f32 v130, v90
  v_sin_f32 v131, v90
  v_cos_f32 v160, v91
  v_sin_f32 v161, v91
  v_cos_f32 v162, v92
  v_sin_f32 v163, v92
  v_pk_mul_f32 v[130:131], v[130:131], v[86:87] op_sel:[0,0] op_sel_hi:[1,0]
  v_pk_mul_f32 v[160:161], v[160:161], v[86:87] op_sel:[0,1] op_sel_hi:[1,1]
  v_pk_mul_f32 v[162:163], v[162:163], v[88:89] op_sel:[0,0] op_sel_hi:[1,0]
  v_pk_mul_f32 v[188:189], v[160:161], v[160:161] op_sel_hi:[1,0]
  v_pk_fma_f32 v[188:189], v[160:161], v[160:161], v[188:189] op_sel:[1,1,0] op_sel_hi:[0,1,1] neg_lo:[1,0,0]
  v_pk_mul_f32 v[190:191], v[188:189], v[188:189] op_sel_hi:[1,0]
  v_pk_fma_f32 v[190:191], v[188:189], v[188:189], v[190:191] op_sel:[1,1,0] op_sel_hi:[0,1,1] neg_lo:[1,0,0]
  v_pk_mul_f32 v[188:189], v[190:191], v[190:191] op_sel_hi:[1,0]
  v_pk_fma_f32 v[188:189], v[190:191], v[190:191], v[188:189] op_sel:[1,1,0] op_sel_hi:[0,1,1] neg_lo:[1,0,0]
  v_pk_mul_f32 v[178:179], v[176:177], v[188:189] op_sel_hi:[1,0]
  v_pk_fma_f32 v[178:179], v[176:177], v[188:189], v[178:179] op_sel:[1,1,0] op_sel_hi:[0,1,1] neg_lo:[1,0,0]
  v_cvt_pk_bf16_f32 v192, v176, -v177
  v_cvt_pk_bf16_f32 v193, v178, -v179
  s_waitcnt vmcnt(6)
  v_dot2c_f32_bf16 v52, s55, v32
  v_dot2c_f32_bf16 v53, v32, v32
  v_dot2c_f32_bf16 v52, s55, v33
  v_dot2c_f32_bf16 v53, v33, v33
  v_dot2c_f32_bf16 v52, s55, v34
  v_dot2c_f32_bf16 v53, v34, v34
  v_dot2c_f32_bf16 v52, s55, v35
  v_dot2c_f32_bf16 v53, v35, v35
  v_dot2c_f32_bf16 v52, s55, v36
  v_dot2c_f32_bf16 v53, v36, v36
  v_dot2c_f32_bf16 v52, s55, v37
  v_dot2c_f32_bf16 v53, v37, v37
  v_dot2c_f32_bf16 v52, s55, v38
  v_dot2c_f32_bf16 v53, v38, v38
  v_dot2c_f32_bf16 v52, s55, v39
  v_dot2c_f32_bf16 v53, v39, v39
  s_nop 1
  v_add_f32 v52, v52, v52 quad_perm:[1,0,3,2]
  v_add_f32 v53, v53, v53 quad_perm:[1,0,3,2]
  s_mul_i32 s4, s68, 0x4000400
  s_and_b32 s4, s4, 0x70007000
  s_xor_b32 s56, s4, 0x1000
  v_add_f32 v52, v52, v52 quad_perm:[2,3,0,1]
  v_add_f32 v53, v53, v53 quad_perm:[2,3,0,1]
  s_xor_b32 s57, s4, 0x20002000
  v_add_f32 v52, v52, v52 row_half_mirror
  v_add_f32 v53, v53, v53 row_half_mirror
  s_xor_b32 s58, s4, 0x40005000
  v_add_f32 v52, v52, v52 row_mirror
  v_add_f32 v53, v53, v53 row_mirror
  s_xor_b32 s59, s4, 0x70003000
  v_add_f32 v52, v52, v52 row_bcast:15 row_mask:0xa
  v_add_f32 v53, v53, v53 row_bcast:15 row_mask:0xa
  v_mul_f32 v52, 0x3b000000, v52
  v_mul_f32 v53, 0x3b000000, v53
  v_fma_f32 v53, -v52, v52, v53
  v_max_f32 v53, 0, v53
  v_add_f32 v53, 0x3727c5ac, v53
  v_rsq_f32 v53, v53
  s_nop 0
  v_mul_f32 v54, 0x3d800000, v53
  v_mul_f32 v52, v52, v54
  v_sub_f32 v55, 0x3bc00000, v52
  ds_write_b64 v17, v[54:55]
  v_pk_mul_f32 v[184:185], v[176:177], v[160:161] op_sel_hi:[1,0]
  v_pk_fma_f32 v[184:185], v[176:177], v[160:161], v[184:185] op_sel:[1,1,0] op_sel_hi:[0,1,1] neg_lo:[1,0,0]
  v_pk_mul_f32 v[186:187], v[178:179], v[160:161] op_sel_hi:[1,0]
  v_pk_fma_f32 v[186:187], v[178:179], v[160:161], v[186:187] op_sel:[1,1,0] op_sel_hi:[0,1,1] neg_lo:[1,0,0]
  v_cvt_pk_bf16_f32 v194, v184, -v185
  v_cvt_pk_bf16_f32 v195, v186, -v187
  v_pk_mul_f32 v[176:177], v[184:185], v[160:161] op_sel_hi:[1,0]
  v_pk_fma_f32 v[176:177], v[184:185], v[160:161], v[176:177] op_sel:[1,1,0] op_sel_hi:[0,1,1] neg_lo:[1,0,0]
  v_pk_mul_f32 v[178:179], v[186:187], v[160:161] op_sel_hi:[1,0]
  v_pk_fma_f32 v[178:179], v[186:187], v[160:161], v[178:179] op_sel:[1,1,0] op_sel_hi:[0,1,1] neg_lo:[1,0,0]
  v_cvt_pk_bf16_f32 v196, v176, -v177
  v_cvt_pk_bf16_f32 v197, v178, -v179
  v_pk_mul_f32 v[184:185], v[176:177], v[160:161] op_sel_hi:[1,0]
  v_pk_fma_f32 v[184:185], v[176:177], v[160:161], v[184:185] op_sel:[1,1,0] op_sel_hi:[0,1,1] neg_lo:[1,0,0]
  v_pk_mul_f32 v[186:187], v[178:179], v[160:161] op_sel_hi:[1,0]
  v_pk_fma_f32 v[186:187], v[178:179], v[160:161], v[186:187] op_sel:[1,1,0] op_sel_hi:[0,1,1] neg_lo:[1,0,0]
  v_cvt_pk_bf16_f32 v198, v184, -v185
  v_cvt_pk_bf16_f32 v199, v186, -v187
  s_mov_b32 s12, 0x40004000
  s_mov_b32 s13, s12
  s_nop 0
  ds_write2st64_b32 v96, v192, v193 offset0:0 offset1:17
  ds_write2st64_b32 v97, v194, v195 offset0:0 offset1:17
  ds_write2st64_b32 v98, v196, v197 offset0:0 offset1:17
  ds_write2st64_b32 v99, v198, v199 offset0:0 offset1:17
  v_pk_mul_f32 v[176:177], v[184:185], v[160:161] op_sel_hi:[1,0]
  v_pk_fma_f32 v[176:177], v[184:185], v[160:161], v[176:177] op_sel:[1,1,0] op_sel_hi:[0,1,1] neg_lo:[1,0,0]
  v_pk_mul_f32 v[178:179], v[186:187], v[160:161] op_sel_hi:[1,0]
  v_pk_fma_f32 v[178:179], v[186:187], v[160:161], v[178:179] op_sel:[1,1,0] op_sel_hi:[0,1,1] neg_lo:[1,0,0]
  v_cvt_pk_bf16_f32 v200, v176, -v177
  v_cvt_pk_bf16_f32 v201, v178, -v179
  v_pk_mul_f32 v[184:185], v[176:177], v[160:161] op_sel_hi:[1,0]
  v_pk_fma_f32 v[184:185], v[176:177], v[160:161], v[184:185] op_sel:[1,1,0] op_sel_hi:[0,1,1] neg_lo:[1,0,0]
  v_pk_mul_f32 v[186:187], v[178:179], v[160:161] op_sel_hi:[1,0]
  v_pk_fma_f32 v[186:187], v[178:179], v[160:161], v[186:187] op_sel:[1,1,0] op_sel_hi:[0,1,1] neg_lo:[1,0,0]
  v_cvt_pk_bf16_f32 v202, v184, -v185
  v_cvt_pk_bf16_f32 v203, v186, -v187
  v_pk_mul_f32 v[176:177], v[184:185], v[160:161] op_sel_hi:[1,0]
  v_pk_fma_f32 v[176:177], v[184:185], v[160:161], v[176:177] op_sel:[1,1,0] op_sel_hi:[0,1,1] neg_lo:[1,0,0]
  v_pk_mul_f32 v[178:179], v[186:187], v[160:161] op_sel_hi:[1,0]
  v_pk_fma_f32 v[178:179], v[186:187], v[160:161], v[178:179] op_sel:[1,1,0] op_sel_hi:[0,1,1] neg_lo:[1,0,0]
  v_cvt_pk_bf16_f32 v204, v176, -v177
  v_cvt_pk_bf16_f32 v205, v178, -v179
  v_pk_mul_f32 v[184:185], v[176:177], v[160:161] op_sel_hi:[1,0]
  v_pk_fma_f32 v[184:185], v[176:177], v[160:161], v[184:185] op_sel:[1,1,0] op_sel_hi:[0,1,1] neg_lo:[1,0,0]
  v_pk_mul_f32 v[186:187], v[178:179], v[160:161] op_sel_hi:[1,0]
  v_pk_fma_f32 v[186:187], v[178:179], v[160:161], v[186:187] op_sel:[1,1,0] op_sel_hi:[0,1,1] neg_lo:[1,0,0]
  v_cvt_pk_bf16_f32 v206, v184, -v185
  v_cvt_pk_bf16_f32 v207, v186, -v187
  s_and_b64 s[70:71], s[70:71], s[12:13]
  s_bcnt1_i32_b64 s70, s[70:71]
  ds_write2st64_b32 v100, v200, v201 offset0:0 offset1:17
  ds_write2st64_b32 v101, v202, v203 offset0:0 offset1:17
  ds_write2st64_b32 v102, v204, v205 offset0:0 offset1:17
  ds_write2st64_b32 v103, v206, v207 offset0:0 offset1:17
  v_pk_mul_f32 v[132:133], v[130:131], v[130:131] op_sel_hi:[1,0]
  v_pk_fma_f32 v[132:133], v[130:131], v[130:131], v[132:133] op_sel:[1,1,0] op_sel_hi:[0,1,1] neg_lo:[1,0,0]
  v_pk_mul_f32 v[136:137], v[132:133], v[132:133] op_sel_hi:[1,0]
  v_pk_fma_f32 v[136:137], v[132:133], v[132:133], v[136:137] op_sel:[1,1,0] op_sel_hi:[0,1,1] neg_lo:[1,0,0]
  v_pk_mul_f32 v[144:145], v[136:137], v[136:137] op_sel_hi:[1,0]
  v_pk_fma_f32 v[144:145], v[136:137], v[136:137], v[144:145] op_sel:[1,1,0] op_sel_hi:[0,1,1] neg_lo:[1,0,0]
  v_mov_b32 v192, 0x3f80
  v_cvt_pk_bf16_f32 v193, v144, v145
  v_pk_mul_f32 v[164:165], v[162:163], v[162:163] op_sel_hi:[1,0]
  v_pk_fma_f32 v[164:165], v[162:163], v[162:163], v[164:165] op_sel:[1,1,0] op_sel_hi:[0,1,1] neg_lo:[1,0,0]
  s_waitcnt lgkmcnt(0)
  s_barrier
  ds_read_b128 v[208:211], v15
  ds_read_b128 v[212:215], v15 offset:16
  s_waitcnt vmcnt(2)
  v_lshlrev_b32 v64, 16, v40
  v_and_b32 v65, 0xffff0000, v40
  v_lshlrev_b32 v66, 16, v41
  v_and_b32 v67, 0xffff0000, v41
  v_lshlrev_b32 v68, 16, v42
  v_and_b32 v69, 0xffff0000, v42
  v_lshlrev_b32 v70, 16, v43
  v_and_b32 v71, 0xffff0000, v43
  v_lshlrev_b32 v72, 16, v44
  v_and_b32 v73, 0xffff0000, v44
  v_lshlrev_b32 v74, 16, v45
  v_and_b32 v75, 0xffff0000, v45
  v_lshlrev_b32 v76, 16, v46
  v_and_b32 v77, 0xffff0000, v46
  v_lshlrev_b32 v78, 16, v47
  v_and_b32 v79, 0xffff0000, v47
  s_mov_b32 s4, 0xbbc00000
  s_waitcnt lgkmcnt(0)
  v_pk_fma_f32 v[64:65], v[64:65], v[208:209], v[208:209] op_sel:[0,0,1] op_sel_hi:[1,0,1]
  v_pk_fma_f32 v[68:69], v[68:69], v[210:211], v[210:211] op_sel:[0,0,1] op_sel_hi:[1,0,1]
  v_pk_fma_f32 v[72:73], v[72:73], v[212:213], v[212:213] op_sel:[0,0,1] op_sel_hi:[1,0,1]
  v_pk_fma_f32 v[76:77], v[76:77], v[214:215], v[214:215] op_sel:[0,0,1] op_sel_hi:[1,0,1]
  v_pk_add_f32 v[64:65], v[64:65], s[4:5] op_sel_hi:[1,0]
  v_pk_add_f32 v[68:69], v[68:69], s[4:5] op_sel_hi:[1,0]
  v_pk_add_f32 v[72:73], v[72:73], s[4:5] op_sel_hi:[1,0]
  v_pk_add_f32 v[76:77], v[76:77], s[4:5] op_sel_hi:[1,0]
  v_cvt_pk_bf16_f32 v40, v64, v68
  v_cvt_pk_bf16_f32 v41, v72, v76
  v_cvt_pk_bf16_f32 v42, v65, v69
  v_cvt_pk_bf16_f32 v43, v73, v77
  v_bfi_b32 v40, v8, s56, v40
  v_bfi_b32 v41, v8, s57, v41
  v_bfi_b32 v42, v8, s58, v42
  v_bfi_b32 v43, v8, s59, v43
  v_pk_fma_f32 v[66:67], v[66:67], v[208:209], v[208:209] op_sel:[0,0,1] op_sel_hi:[1,0,1]
  v_pk_fma_f32 v[70:71], v[70:71], v[210:211], v[210:211] op_sel:[0,0,1] op_sel_hi:[1,0,1]
  v_pk_fma_f32 v[74:75], v[74:75], v[212:213], v[212:213] op_sel:[0,0,1] op_sel_hi:[1,0,1]
  v_pk_fma_f32 v[78:79], v[78:79], v[214:215], v[214:215] op_sel:[0,0,1] op_sel_hi:[1,0,1]
  v_pk_add_f32 v[66:67], v[66:67], s[4:5] op_sel_hi:[1,0]
  v_pk_add_f32 v[70:71], v[70:71], s[4:5] op_sel_hi:[1,0]
  v_pk_add_f32 v[74:75], v[74:75], s[4:5] op_sel_hi:[1,0]
  v_pk_add_f32 v[78:79], v[78:79], s[4:5] op_sel_hi:[1,0]
  v_cvt_pk_bf16_f32 v44, v66, v70
  v_cvt_pk_bf16_f32 v45, v74, v78
  v_cvt_pk_bf16_f32 v46, v67, v71
  v_cvt_pk_bf16_f32 v47, v75, v79
  v_bfi_b32 v44, v8, s56, v44
  v_bfi_b32 v45, v8, s57, v45
  v_bfi_b32 v46, v8, s58, v46
  v_bfi_b32 v47, v8, s59, v47
L_hop13:
  s_cbranch_execz L_wx
  buffer_store_dwordx4 v[40:43], v3, s[36:39], s82 offen offset:0 sc1
  buffer_store_dwordx4 v[44:47], v3, s[36:39], s82 offen offset:1024 sc1
  s_xor_b32 s56, s56, s22
  s_xor_b32 s57, s57, s22
  s_xor_b32 s58, s58, s22
  s_xor_b32 s59, s59, s22
  s_nop 0
  v_pk_mul_f32 v[146:147], v[144:145], v[130:131] op_sel_hi:[1,0]
  v_pk_fma_f32 v[146:147], v[144:145], v[130:131], v[146:147] op_sel:[1,1,0] op_sel_hi:[0,1,1] neg_lo:[1,0,0]
  v_cvt_pk_bf16_f32 v194, v130, v131
  v_cvt_pk_bf16_f32 v195, v146, v147
  v_pk_mul_f32 v[166:167], v[164:165], v[162:163] op_sel_hi:[1,0]
  v_pk_fma_f32 v[166:167], v[164:165], v[162:163], v[166:167] op_sel:[1,1,0] op_sel_hi:[0,1,1] neg_lo:[1,0,0]
  v_pk_mul_f32 v[148:149], v[144:145], v[132:133] op_sel_hi:[1,0]
  v_pk_fma_f32 v[148:149], v[144:145], v[132:133], v[148:149] op_sel:[1,1,0] op_sel_hi:[0,1,1] neg_lo:[1,0,0]
  v_cvt_pk_bf16_f32 v196, v132, v133
  v_cvt_pk_bf16_f32 v197, v148, v149
  v_pk_mul_f32 v[134:135], v[132:133], v[130:131] op_sel_hi:[1,0]
  v_pk_fma_f32 v[134:135], v[132:133], v[130:131], v[134:135] op_sel:[1,1,0] op_sel_hi:[0,1,1] neg_lo:[1,0,0]
  v_pk_mul_f32 v[150:151], v[144:145], v[134:135] op_sel_hi:[1,0]
  v_pk_fma_f32 v[150:151], v[144:145], v[134:135], v[150:151] op_sel:[1,1,0] op_sel_hi:[0,1,1] neg_lo:[1,0,0]
  v_cvt_pk_bf16_f32 v198, v134, v135
  v_cvt_pk_bf16_f32 v199, v150, v151
  s_and_b64 s[72:73], s[72:73], s[12:13]
  s_bcnt1_i32_b64 s72, s[72:73]
  ds_write2st64_b32 v96, v192, v193 offset0:34 offset1:51
  ds_write2st64_b32 v97, v194, v195 offset0:34 offset1:51
  ds_write2st64_b32 v98, v196, v197 offset0:34 offset1:51
  ds_write2st64_b32 v99, v198, v199 offset0:34 offset1:51
  v_pk_mul_f32 v[168:169], v[164:165], v[164:165] op_sel_hi:[1,0]
  v_pk_fma_f32 v[168:169], v[164:165], v[164:165], v[168:169] op_sel:[1,1,0] op_sel_hi:[0,1,1] neg_lo:[1,0,0]
  v_pk_mul_f32 v[152:153], v[144:145], v[136:137] op_sel_hi:[1,0]
  v_pk_fma_f32 v[152:153], v[144:145], v[136:137], v[152:153] op_sel:[1,1,0] op_sel_hi:[0,1,1] neg_lo:[1,0,0]
  v_cvt_pk_bf16_f32 v200, v136, v137
  v_cvt_pk_bf16_f32 v201, v152, v153
  v_pk_mul_f32 v[138:139], v[136:137], v[130:131] op_sel_hi:[1,0]
  v_pk_fma_f32 v[138:139], v[136:137], v[130:131], v[138:139] op_sel:[1,1,0] op_sel_hi:[0,1,1] neg_lo:[1,0,0]
  v_pk_mul_f32 v[154:155], v[144:145], v[138:139] op_sel_hi:[1,0]
  v_pk_fma_f32 v[154:155], v[144:145], v[138:139], v[154:155] op_sel:[1,1,0] op_sel_hi:[0,1,1] neg_lo:[1,0,0]
  v_cvt_pk_bf16_f32 v202, v138, v139
  v_cvt_pk_bf16_f32 v203, v154, v155
  v_pk_mul_f32 v[140:141], v[136:137], v[132:133] op_sel_hi:[1,0]
  v_pk_fma_f32 v[140:141], v[136:137], v[132:133], v[140:141] op_sel:[1,1,0] op_sel_hi:[0,1,1] neg_lo:[1,0,0]
  v_pk_mul_f32 v[156:157], v[144:145], v[140:141] op_sel_hi:[1,0]
  v_pk_fma_f32 v[156:157], v[144:145], v[140:141], v[156:157] op_sel:[1,1,0] op_sel_hi:[0,1,1] neg_lo:[1,0,0]
  v_cvt_pk_bf16_f32 v204, v140, v141
  v_cvt_pk_bf16_f32 v205, v156, v157
  v_pk_mul_f32 v[142:143], v[136:137], v[134:135] op_sel_hi:[1,0]
  v_pk_fma_f32 v[142:143], v[136:137], v[134:135], v[142:143] op_sel:[1,1,0] op_sel_hi:[0,1,1] neg_lo:[1,0,0]
  v_pk_mul_f32 v[158:159], v[144:145], v[142:143] op_sel_hi:[1,0]
  v_pk_fma_f32 v[158:159], v[144:145], v[142:143], v[158:159] op_sel:[1,1,0] op_sel_hi:[0,1,1] neg_lo:[1,0,0]
  v_cvt_pk_bf16_f32 v206, v142, v143
  v_cvt_pk_bf16_f32 v207, v158, v159
  s_and_b64 s[74:75], s[74:75], s[12:13]
  s_bcnt1_i32_b64 s74, s[74:75]
  ds_write2st64_b32 v100, v200, v201 offset0:34 offset1:51
  ds_write2st64_b32 v101, v202, v203 offset0:34 offset1:51
  ds_write2st64_b32 v102, v204, v205 offset0:34 offset1:51
  ds_write2st64_b32 v103, v206, v207 offset0:34 offset1:51
  s_add_u32 s84, s82, 8388608
  buffer_store_dwordx4 v[56:59], v3, s[36:39], s84 offen offset:0 sc1
  buffer_store_dwordx4 v[56:59], v3, s[36:39], s84 offen offset:1024 sc1
  s_add_u32 m0, s96, 0
  s_add_u32 s78, s86, 0
  buffer_load_dwordx4 v20, s[40:43], s78 offen offset:0  lds
  buffer_load_dwordx4 v21, s[40:43], s78 offen offset:1024  lds
  buffer_load_dwordx4 v22, s[40:43], s78 offen offset:2048  lds
  buffer_load_dwordx4 v23, s[40:43], s78 offen offset:3072  lds
  v_pk_mul_f32 v[188:189], v[162:163], v[160:161] op_sel_hi:[1,0]
  v_pk_fma_f32 v[188:189], v[162:163], v[160:161], v[188:189] op_sel:[1,1,0] op_sel_hi:[0,1,1] neg_lo:[1,0,0]
  v_pk_mul_f32 v[190:191], v[164:165], v[152:153] op_sel_hi:[1,0]
  v_pk_fma_f32 v[190:191], v[164:165], v[152:153], v[190:191] op_sel:[1,1,0] op_sel_hi:[0,1,1] neg_lo:[1,0,0]
  v_cvt_pk_bf16_f32 v192, v188, v189
  v_cvt_pk_bf16_f32 v193, v190, v191
  v_pk_mul_f32 v[188:189], v[162:163], v[140:141] op_sel_hi:[1,0]
  v_pk_fma_f32 v[188:189], v[162:163], v[140:141], v[188:189] op_sel:[1,1,0] op_sel_hi:[0,1,1] neg_lo:[1,0,0]
  v_cvt_pk_bf16_f32 v194, v188, v189
  v_cvt_pk_bf16_f32 v195, v160, v161
  v_pk_mul_f32 v[188:189], v[162:163], v[136:137] op_sel_hi:[1,0]
  v_pk_fma_f32 v[188:189], v[162:163], v[136:137], v[188:189] op_sel:[1,1,0] op_sel_hi:[0,1,1] neg_lo:[1,0,0]
  v_cvt_pk_bf16_f32 v196, v188, v189
  v_cvt_pk_bf16_f32 v197, v164, v165
  v_pk_mul_f32 v[188:189], v[162:163], v[132:133] op_sel_hi:[1,0]
  v_pk_fma_f32 v[188:189], v[162:163], v[132:133], v[188:189] op_sel:[1,1,0] op_sel_hi:[0,1,1] neg_lo:[1,0,0]
  v_pk_mul_f32 v[190:191], v[162:163], v[144:145] op_sel_hi:[1,0]
  v_pk_fma_f32 v[190:191], v[162:163], v[144:145], v[190:191] op_sel:[1,1,0] op_sel_hi:[0,1,1] neg_lo:[1,0,0]
  v_cvt_pk_bf16_f32 v198, v188, v189
  v_cvt_pk_bf16_f32 v199, v190, v191
  s_add_u32 s70, s70, s72
  s_add_u32 s70, s70, s74
  ds_write2st64_b32 v96, v192, v193 offset0:68 offset1:85
  ds_write2st64_b32 v97, v194, v195 offset0:68 offset1:85
  ds_write2st64_b32 v98, v196, v197 offset0:68 offset1:85
  ds_write2st64_b32 v99, v198, v199 offset0:68 offset1:85
  v_pk_mul_f32 v[188:189], v[164:165], v[160:161] op_sel_hi:[1,0]
  v_pk_fma_f32 v[188:189], v[164:165], v[160:161], v[188:189] op_sel:[1,1,0] op_sel_hi:[0,1,1] neg_lo:[1,0,0]
  v_pk_mul_f32 v[190:191], v[166:167], v[160:161] op_sel_hi:[1,0]
  v_pk_fma_f32 v[190:191], v[166:167], v[160:161], v[190:191] op_sel:[1,1,0] op_sel_hi:[0,1,1] neg_lo:[1,0,0]
  v_cvt_pk_bf16_f32 v200, v188, v189
  v_cvt_pk_bf16_f32 v201, v190, v191
  v_pk_mul_f32 v[188:189], v[162:163], v[148:149] op_sel_hi:[1,0]
  v_pk_fma_f32 v[188:189], v[162:163], v[148:149], v[188:189] op_sel:[1,1,0] op_sel_hi:[0,1,1] neg_lo:[1,0,0]
  v_pk_mul_f32 v[190:191], v[162:163], v[156:157] op_sel_hi:[1,0]
  v_pk_fma_f32 v[190:191], v[162:163], v[156:157], v[190:191] op_sel:[1,1,0] op_sel_hi:[0,1,1] neg_lo:[1,0,0]
  v_cvt_pk_bf16_f32 v202, v188, v189
  v_cvt_pk_bf16_f32 v203, v190, v191
  v_pk_mul_f32 v[188:189], v[162:163], v[152:153] op_sel_hi:[1,0]
  v_pk_fma_f32 v[188:189], v[162:163], v[152:153], v[188:189] op_sel:[1,1,0] op_sel_hi:[0,1,1] neg_lo:[1,0,0]
  v_pk_mul_f32 v[190:191], v[164:165], v[136:137] op_sel_hi:[1,0]
  v_pk_fma_f32 v[190:191], v[164:165], v[136:137], v[190:191] op_sel:[1,1,0] op_sel_hi:[0,1,1] neg_lo:[1,0,0]
  v_cvt_pk_bf16_f32 v204, v188, v189
  v_cvt_pk_bf16_f32 v205, v190, v191
  v_pk_mul_f32 v[190:191], v[166:167], v[144:145] op_sel_hi:[1,0]
  v_pk_fma_f32 v[190:191], v[166:167], v[144:145], v[190:191] op_sel:[1,1,0] op_sel_hi:[0,1,1] neg_lo:[1,0,0]
  v_cvt_pk_bf16_f32 v206, v162, v163
  v_cvt_pk_bf16_f32 v207, v190, v191
  s_cmp_lt_u32 s70, 6
  s_nop 0
  s_cselect_b32 s48, s12, 0x20002000
  ds_write2st64_b32 v100, v200, v201 offset0:68 offset1:85
  ds_write2st64_b32 v101, v202, v203 offset0:68 offset1:85
  ds_write2st64_b32 v102, v204, v205 offset0:68 offset1:85
  ds_write2st64_b32 v103, v206, v207 offset0:68 offset1:85
  v_pk_mul_f32 v[188:189], v[166:167], v[152:153] op_sel_hi:[1,0]
  v_pk_fma_f32 v[188:189], v[166:167], v[152:153], v[188:189] op_sel:[1,1,0] op_sel_hi:[0,1,1] neg_lo:[1,0,0]
  v_pk_mul_f32 v[174:175], v[168:169], v[166:167] op_sel_hi:[1,0]
  v_pk_fma_f32 v[174:175], v[168:169], v[166:167], v[174:175] op_sel:[1,1,0] op_sel_hi:[0,1,1] neg_lo:[1,0,0]
  v_cvt_pk_bf16_f32 v192, v188, v189
  v_cvt_pk_bf16_f32 v193, v174, v175
  v_pk_mul_f32 v[188:189], v[164:165], v[144:145] op_sel_hi:[1,0]
  v_pk_fma_f32 v[188:189], v[164:165], v[144:145], v[188:189] op_sel:[1,1,0] op_sel_hi:[0,1,1] neg_lo:[1,0,0]
  v_pk_mul_f32 v[170:171], v[168:169], v[162:163] op_sel_hi:[1,0]
  v_pk_fma_f32 v[170:171], v[168:169], v[162:163], v[170:171] op_sel:[1,1,0] op_sel_hi:[0,1,1] neg_lo:[1,0,0]
  v_cvt_pk_bf16_f32 v194, v188, v189
  v_cvt_pk_bf16_f32 v195, v170, v171
  v_pk_mul_f32 v[172:173], v[168:169], v[164:165] op_sel_hi:[1,0]
  v_pk_fma_f32 v[172:173], v[168:169], v[164:165], v[172:173] op_sel:[1,1,0] op_sel_hi:[0,1,1] neg_lo:[1,0,0]
  v_cvt_pk_bf16_f32 v196, v168, v169
  v_cvt_pk_bf16_f32 v197, v172, v173
  v_pk_mul_f32 v[188:189], v[168:169], v[144:145] op_sel_hi:[1,0]
  v_pk_fma_f32 v[188:189], v[168:169], v[144:145], v[188:189] op_sel:[1,1,0] op_sel_hi:[0,1,1] neg_lo:[1,0,0]
  v_pk_mul_f32 v[190:191], v[172:173], v[144:145] op_sel_hi:[1,0]
  v_pk_fma_f32 v[190:191], v[172:173], v[144:145], v[190:191] op_sel:[1,1,0] op_sel_hi:[0,1,1] neg_lo:[1,0,0]
  v_cvt_pk_bf16_f32 v198, v188, v189
  v_cvt_pk_bf16_f32 v199, v190, v191
  s_add_u32 s54, s68, 1
  s_nop 0
  ds_write2st64_b32 v96, v192, v193 offset0:102 offset1:119
  ds_write2st64_b32 v97, v194, v195 offset0:102 offset1:119
  ds_write2st64_b32 v98, v196, v197 offset0:102 offset1:119
  ds_write2st64_b32 v99, v198, v199 offset0:102 offset1:119
  v_pk_mul_f32 v[188:189], v[172:173], v[160:161] op_sel_hi:[1,0]
  v_pk_fma_f32 v[188:189], v[172:173], v[160:161], v[188:189] op_sel:[1,1,0] op_sel_hi:[0,1,1] neg_lo:[1,0,0]
  v_pk_mul_f32 v[190:191], v[174:175], v[144:145] op_sel_hi:[1,0]
  v_pk_fma_f32 v[190:191], v[174:175], v[144:145], v[190:191] op_sel:[1,1,0] op_sel_hi:[0,1,1] neg_lo:[1,0,0]
  v_cvt_pk_bf16_f32 v200, v188, v189
  v_cvt_pk_bf16_f32 v201, v190, v191
  v_pk_mul_f32 v[190:191], v[170:171], v[144:145] op_sel_hi:[1,0]
  v_pk_fma_f32 v[190:191], v[170:171], v[144:145], v[190:191] op_sel:[1,1,0] op_sel_hi:[0,1,1] neg_lo:[1,0,0]
  v_cvt_pk_bf16_f32 v202, v166, v167
  v_cvt_pk_bf16_f32 v203, v190, v191
  v_pk_mul_f32 v[188:189], v[166:167], v[136:137] op_sel_hi:[1,0]
  v_pk_fma_f32 v[188:189], v[166:167], v[136:137], v[188:189] op_sel:[1,1,0] op_sel_hi:[0,1,1] neg_lo:[1,0,0]
  v_pk_mul_f32 v[190:191], v[168:169], v[160:161] op_sel_hi:[1,0]
  v_pk_fma_f32 v[190:191], v[168:169], v[160:161], v[190:191] op_sel:[1,1,0] op_sel_hi:[0,1,1] neg_lo:[1,0,0]
  v_cvt_pk_bf16_f32 v204, v188, v189
  v_cvt_pk_bf16_f32 v205, v190, v191
  v_pk_mul_f32 v[188:189], v[170:171], v[160:161] op_sel_hi:[1,0]
  v_pk_fma_f32 v[188:189], v[170:171], v[160:161], v[188:189] op_sel:[1,1,0] op_sel_hi:[0,1,1] neg_lo:[1,0,0]
  v_pk_mul_f32 v[190:191], v[174:175], v[160:161] op_sel_hi:[1,0]
  v_pk_fma_f32 v[190:191], v[174:175], v[160:161], v[190:191] op_sel:[1,1,0] op_sel_hi:[0,1,1] neg_lo:[1,0,0]
  v_cvt_pk_bf16_f32 v206, v188, v189
  v_cvt_pk_bf16_f32 v207, v190, v191
  ds_write2st64_b32 v100, v200, v201 offset0:102 offset1:119
  ds_write2st64_b32 v101, v202, v203 offset0:102 offset1:119
  ds_write2st64_b32 v102, v204, v205 offset0:102 offset1:119
  ds_write2st64_b32 v103, v206, v207 offset0:102 offset1:119
  s_waitcnt lgkmcnt(0)
  s_barrier
  ds_read_b128 v[128:131], v104 offset:0
  ds_read_b128 v[132:135], v105 offset:0
  ds_read_b128 v[136:139], v106 offset:0
  ds_read_b128 v[140:143], v104 offset:64
  ds_read_b128 v[144:147], v105 offset:64
  ds_read_b128 v[148:151], v106 offset:64
  ds_read_b128 v[152:155], v104 offset:128
  ds_read_b128 v[156:159], v105 offset:128
  ds_read_b128 v[160:163], v106 offset:128
  ds_read_b128 v[164:167], v104 offset:192
  ds_read_b128 v[168:171], v105 offset:192
  ds_read_b128 v[172:175], v106 offset:192
  s_waitcnt lgkmcnt(9)
  v_mfma_f32_16x16x32_bf16 v[64:67], v[132:135], v[128:131], 0
  v_mfma_f32_16x16x32_bf16 v[68:71], v[136:139], v[128:131], 0
  ds_read_b128 v[176:179], v104 offset:256
  ds_read_b128 v[180:183], v105 offset:256
  ds_read_b128 v[184:187], v106 offset:256
  s_waitcnt lgkmcnt(9)
  v_mfma_f32_16x16x32_bf16 v[64:67], v[144:147], v[140:143], v[64:67]
  v_mfma_f32_16x16x32_bf16 v[68:71], v[148:151], v[140:143], v[68:71]
  ds_read_b128 v[188:191], v104 offset:320
  ds_read_b128 v[192:195], v105 offset:320
  ds_read_b128 v[196:199], v106 offset:320
  s_waitcnt lgkmcnt(9)
  v_mfma_f32_16x16x32_bf16 v[64:67], v[156:159], v[152:155], v[64:67]
  v_mfma_f32_16x16x32_bf16 v[68:71], v[160:163], v[152:155], v[68:71]
  ds_read_b128 v[200:203], v104 offset:384
  ds_read_b128 v[204:207], v105 offset:384
  ds_read_b128 v[208:211], v106 offset:384
  s_waitcnt lgkmcnt(9)
  v_mfma_f32_16x16x32_bf16 v[64:67], v[168:171], v[164:167], v[64:67]
  v_mfma_f32_16x16x32_bf16 v[68:71], v[172:175], v[164:167], v[68:71]
  ds_read_b128 v[212:215], v104 offset:448
  ds_read_b128 v[216:219], v105 offset:448
  ds_read_b128 v[220:223], v106 offset:448
  buffer_load_dwordx4 v[32:35], v14, s[36:39], s97 offen sc1
  buffer_load_dwordx4 v[36:39], v14, s[36:39], s98 offen sc1
  s_add_u32 m0, s96, 4096
  s_waitcnt lgkmcnt(9)
  v_mfma_f32_16x16x32_bf16 v[64:67], v[180:183], v[176:179], v[64:67]
  v_mfma_f32_16x16x32_bf16 v[68:71], v[184:187], v[176:179], v[68:71]
  s_add_u32 s78, s86, 57344
  s_waitcnt lgkmcnt(6)
  v_mfma_f32_16x16x32_bf16 v[64:67], v[192:195], v[188:191], v[64:67]
  v_mfma_f32_16x16x32_bf16 v[68:71], v[196:199], v[188:191], v[68:71]
  buffer_load_dwordx4 v20, s[40:43], s78 offen offset:0  lds
  s_waitcnt lgkmcnt(3)
  v_mfma_f32_16x16x32_bf16 v[64:67], v[204:207], v[200:203], v[64:67]
  v_mfma_f32_16x16x32_bf16 v[68:71], v[208:211], v[200:203], v[68:71]
  buffer_load_dwordx4 v21, s[40:43], s78 offen offset:1024  lds
  s_waitcnt lgkmcnt(0)
  v_mfma_f32_16x16x32_bf16 v[64:67], v[216:219], v[212:215], v[64:67]
  v_mfma_f32_16x16x32_bf16 v[68:71], v[220:223], v[212:215], v[68:71]
  buffer_load_dwordx4 v22, s[40:43], s78 offen offset:2048  lds
  v_and_b32 v27, 127, v0
  v_cmp_eq_u32 vcc, 0, v27
  v_lshlrev_b32 v27, 16, v95
  v_mul_f32 v27, 0x41800000, v27
  v_cndmask_b32 v27, 0, v27, vcc
  s_bitcmp1_b32 s6, 0
  s_nop 0
  s_cbranch_scc1 L_kw1
  s_or_b32 s76, s2, s6
  s_cbranch_scc1 L_np1
  s_load_dword s79, s[36:37], 0x40000
  s_load_dword s76, s[36:37], 0x42280
L_np1:
  v_add_f32_e64 v64, v64, v27
  v_cvt_pk_bf16_f32 v40, v67, v66
  v_cvt_pk_bf16_f32 v41, v65, v64
  v_cvt_pk_bf16_f32 v42, v71, v67
  v_cvt_pk_bf16_f32 v43, v66, v65
  v_cvt_pk_bf16_f32 v44, v70, v69
  v_cvt_pk_bf16_f32 v45, v68, v68
  v_cvt_pk_bf16_f32 v46, v70, v70
  v_cvt_pk_bf16_f32 v47, v69, v68
  s_mov_b64 exec, 1
  ds_write_b16_d16_hi v11, v41 offset:8256
  s_mov_b64 exec, -1
  ds_write_b64 v11, v[40:41] offset:4088
  ds_write_b64 v11, v[42:43] offset:8248
  ds_write_b64 v11, v[44:45] offset:3576
  ds_write_b64 v11, v[46:47] offset:7736
  s_cbranch_scc1 L_kw2
  s_waitcnt lgkmcnt(1)
  s_add_u32 s4, s54, 1
  v_mov_b32 v54, s54
  v_mov_b32 v55, s4
  s_mov_b32 s4, 323968
  s_add_u32 s5, s54, 3
  v_mov_b32 v49, s48
  v_writelane_b32 v49, s5, 0
  v_and_b32 v50, 7, v1
  v_lshlrev_b32 v50, 2, v50
  v_cmp_lt_u32 vcc, 7, v1
  s_nop 1
  v_cndmask_b32 v50, v50, v56, vcc
  s_cmp_lg_u32 s76, 0
  s_cselect_b64 vcc, -1, 0
  v_cndmask_b32 v54, v54, v55, vcc
  buffer_store_dword v54, off, s[36:39], s4 sc1
  s_branch L_kw2
L_kw1:
  v_cvt_pk_bf16_f32 v40, v66, v66
  v_cvt_pk_bf16_f32 v41, v65, v65
  v_cvt_pk_bf16_f32 v42, v65, v64
  v_cvt_pk_bf16_f32 v43, v64, v64
  v_cvt_pk_bf16_f32 v44, v66, v66
  v_cvt_pk_bf16_f32 v45, v66, v65
  v_cvt_pk_bf16_f32 v46, v65, v65
  v_cvt_pk_bf16_f32 v47, v64, v64
  v_cvt_pk_bf16_f32 v72, v68, v68
  v_cvt_pk_bf16_f32 v73, v68, v68
  v_cvt_pk_bf16_f32 v74, v69, v70
  s_mov_b64 exec, 1
  ds_write_b16 v12, v72 offset:2038
  ds_write_b64 v12, v[72:73] offset:2040
  ds_write_b64 v12, v[72:73] offset:6200
  s_mov_b64 exec, -1
  ds_write_b32 v13, v74
  ds_write_b128 v12, v[40:43] offset:3056
  ds_write_b128 v12, v[44:47] offset:7216
L_kw2:
  buffer_load_dwordx4 v23, s[40:43], s78 offen offset:3072  lds
  s_waitcnt vmcnt(4)
L_h1chk:
  v_xor_b32 v32, s56, v32
  v_xor_b32 v33, s57, v33
  v_xor_b32 v34, s58, v34
  v_xor_b32 v35, s59, v35
  v_xor_b32 v36, s56, v36
  v_xor_b32 v37, s57, v37
  v_xor_b32 v38, s58, v38
  v_xor_b32 v39, s59, v39
  v_bitop3_b32 v40, v32, v33, s22 bitop3:0x7e
  v_bitop3_b32 v41, v34, v35, s22 bitop3:0x7e
  v_bitop3_b32 v42, v36, v37, s22 bitop3:0x7e
  v_bitop3_b32 v43, v38, v39, s22 bitop3:0x7e
  v_or3_b32 v40, v40, v41, v42
  v_bitop3_b32 v40, v40, v43, v8 bitop3:0xa8
  v_cmp_ne_u32 vcc, 0, v40
  ds_write_b64 v16, v[32:33] offset:0
  ds_write_b64 v16, v[34:35] offset:4576
  ds_write_b64 v16, v[36:37] offset:2048
  ds_write_b64 v16, v[38:39] offset:6624
  s_cbranch_vccnz L_h1retry
L_h1ok:
  s_waitcnt lgkmcnt(0)
  s_barrier
  s_nop 0
  ds_read2_b32 a[128:129], v116 offset0:176 offset1:177
  ds_read2_b32 a[130:131], v116 offset0:178 offset1:179
  ds_read_b128 a[160:163], v115 offset:192
  ds_read2_b32 a[132:133], v116 offset0:48 offset1:49
  ds_read2_b32 a[134:135], v116 offset0:50 offset1:51
  ds_read_b128 a[164:167], v115 offset:704
  ds_read2_b32 a[136:137], v117 offset0:176 offset1:177
  ds_read2_b32 a[138:139], v117 offset0:178 offset1:179
  ds_read_b128 a[168:171], v115 offset:1216
  ds_read2_b32 a[140:141], v117 offset0:48 offset1:49
  ds_read2_b32 a[142:143], v117 offset0:50 offset1:51
  ds_read_b128 a[172:175], v115 offset:1728
  s_or_b32 s4, s2, s6
  s_cbranch_scc1 L_noepoch
  buffer_store_dword v49, v50, s[36:39], 0 offen sc1
L_noepoch:
  s_waitcnt lgkmcnt(9)
  v_mfma_f32_16x16x32_bf16 v[64:67], a[128:131], a[160:163], 0
  s_waitcnt lgkmcnt(6)
  ds_read2_b32 a[144:145], v118 offset0:176 offset1:177
  v_mfma_f32_16x16x32_bf16 v[68:71], a[128:131], a[164:167], 0
  s_add_u32 m0, s96, 8192
  ds_read2_b32 a[146:147], v118 offset0:178 offset1:179
  v_mfma_f32_16x16x32_bf16 v[68:71], a[132:135], a[160:163], v[68:71]
  s_waitcnt lgkmcnt(5)
  ds_read_b128 a[176:179], v115 offset:2240
  s_lshl_b32 s81, s3, 6
  v_mfma_f32_16x16x32_bf16 v[72:75], a[128:131], a[168:171], 0
  s_and_b32 s81, s81, 8192
  ds_read_b128 a[180:183], v115 offset:2752
  s_add_u32 s78, s86, 114688
  v_mfma_f32_16x16x32_bf16 v[72:75], a[132:135], a[164:167], v[72:75]
  ds_read_b128 a[184:187], v115 offset:3264
  v_mfma_f32_16x16x32_bf16 v[72:75], a[136:139], a[160:163], v[72:75]
  s_waitcnt lgkmcnt(5)
  ds_read_b128 a[188:191], v115 offset:3776
  s_and_b32 s83, s3, 127
  v_mfma_f32_16x16x32_bf16 v[76:79], a[128:131], a[172:175], 0
  s_lshl_b32 s83, s83, 14
  ds_read2_b32 a[192:193], v116 offset0:160 offset1:161
  buffer_load_dwordx4 v20, s[40:43], s78 offen offset:0  lds
  v_mfma_f32_16x16x32_bf16 v[76:79], a[132:135], a[168:171], v[76:79]
  s_sub_u32 s83, s83, s81
  ds_read2_b32 a[194:195], v116 offset0:162 offset1:163
  v_mfma_f32_16x16x32_bf16 v[76:79], a[136:139], a[164:167], v[76:79]
  s_add_u32 s83, s83, 6299648
  buffer_load_dwordx4 v21, s[40:43], s78 offen offset:1024  lds
  v_mfma_f32_16x16x32_bf16 v[76:79], a[140:143], a[160:163], v[76:79]
  s_waitcnt lgkmcnt(5)
  ds_read_b128 a[224:227], v115 offset:128
  v_lshl_add_u32 v60, v19, 2, v18
  v_mfma_f32_16x16x32_bf16 v[80:83], a[128:131], a[176:179], 0
  s_movk_i32 s13, 8192
  ds_read2_b32 a[196:197], v116 offset0:32 offset1:33
  v_mfma_f32_16x16x32_bf16 v[80:83], a[132:135], a[172:175], v[80:83]
  s_and_b32 s11, s6, 1
  ds_read2_b32 a[198:199], v116 offset0:34 offset1:35
  buffer_load_dwordx4 v22, s[40:43], s78 offen offset:2048  lds
  v_and_b32 v60, 15, v60
  v_mfma_f32_16x16x32_bf16 v[80:83], a[136:139], a[168:171], v[80:83]
  s_lshl_b32 s10, s11, 20
  ds_read_b128 a[228:231], v115 offset:640
  v_mfma_f32_16x16x32_bf16 v[80:83], a[140:143], a[164:167], v[80:83]
  s_lshl_b32 s12, s3, 5
  ds_read2_b32 a[200:201], v117 offset0:160 offset1:161
  buffer_load_dwordx4 v23, s[40:43], s78 offen offset:3072  lds
  v_lshlrev_b32 v60, 4, v60
  v_mfma_f32_16x16x32_bf16 v[80:83], a[144:147], a[160:163], v[80:83]
  s_waitcnt lgkmcnt(9)
  v_mfma_f32_16x16x32_bf16 v[84:87], a[128:131], a[180:183], 0
  s_andn2_b32 s12, s12, 0
  ds_read2_b32 a[202:203], v117 offset0:162 offset1:163
  v_lshl_add_u32 v109, v19, 8, v60
  v_mfma_f32_16x16x32_bf16 v[84:87], a[132:135], a[176:179], v[84:87]
  s_add_u32 s10, s10, s12
  ds_read_b128 a[232:235], v115 offset:1152
  s_add_u32 m0, s96, 12288
  v_mfma_f32_16x16x32_bf16 v[84:87], a[136:139], a[172:175], v[84:87]
  s_xor_b32 s12, s10, 0
  ds_read2_b32 a[204:205], v117 offset0:32 offset1:33
  s_add_u32 s4, s95, 131072
  v_mfma_f32_16x16x32_bf16 v[84:87], a[140:143], a[168:171], v[84:87]
  s_add_u32 s78, s86, 172032
  ds_read2_b32 a[206:207], v117 offset0:34 offset1:35
  v_mfma_f32_16x16x32_bf16 v[84:87], a[144:147], a[164:167], v[84:87]
  s_waitcnt lgkmcnt(12)
  s_add_u32 s60, s10, 6291456
  v_add_u32 v109, s4, v109
  v_mfma_f32_16x16x32_bf16 v[88:91], a[128:131], a[184:187], 0
  s_add_u32 s61, s12, 6307840
  ds_read_b128 a[236:239], v115 offset:1664
  v_mfma_f32_16x16x32_bf16 v[88:91], a[132:135], a[180:183], v[88:91]
  s_add_u32 s62, s10, 6324224
  ds_read_b128 a[240:243], v115 offset:2176
  buffer_load_dwordx4 v20, s[40:43], s78 offen offset:0  lds
  v_mfma_f32_16x16x32_bf16 v[88:91], a[136:139], a[176:179], v[88:91]
  s_add_u32 s63, s12, 6340608
  ds_read_b128 a[244:247], v115 offset:2688
  v_lshrrev_b32 v60, 2, v1
  v_mfma_f32_16x16x32_bf16 v[88:91], a[140:143], a[172:175], v[88:91]
  ds_read_b128 a[248:251], v115 offset:3200
  buffer_load_dwordx4 v21, s[40:43], s78 offen offset:1024  lds
  v_mfma_f32_16x16x32_bf16 v[88:91], a[144:147], a[168:171], v[88:91]
  s_waitcnt lgkmcnt(15)
  ds_read_b128 a[252:255], v115 offset:3712
  s_add_u32 s64, s10, 6815744
  v_lshl_add_u32 v60, v30, 2, v60
  v_mfma_f32_16x16x32_bf16 v[92:95], a[128:131], a[188:191], 0
  s_add_u32 s65, s12, 6832128
  v_mfma_f32_16x16x32_bf16 v[92:95], a[132:135], a[184:187], v[92:95]
  s_add_u32 s66, s10, 6848512
  ds_read2_b64 a[148:151], v114 offset0:23 offset1:24
  buffer_load_dwordx4 v22, s[40:43], s78 offen offset:2048  lds
  v_and_b32 v60, 15, v60
  v_mfma_f32_16x16x32_bf16 v[92:95], a[136:139], a[180:183], v[92:95]
  s_add_u32 s67, s12, 6864896
  ds_read2_b64 a[152:155], v114 offset0:151 offset1:152
  v_mfma_f32_16x16x32_bf16 v[92:95], a[140:143], a[176:179], v[92:95]
  buffer_load_dwordx4 v23, s[40:43], s78 offen offset:3072  lds
  v_lshlrev_b32 v60, 4, v60
  v_mfma_f32_16x16x32_bf16 v[92:95], a[144:147], a[172:175], v[92:95]
  s_waitcnt lgkmcnt(15)
  s_bfe_u32 s10, s3, 0x50002
  v_mfma_f32_16x16x32_bf16 v[64:67], a[192:195], a[224:227], v[64:67]
  s_waitcnt lgkmcnt(12)
  ds_read2_b32 a[128:129], v116 offset0:144 offset1:145
  s_lshl2_add_u32 s10, s10, s6
  v_lshl_add_u32 v110, v30, 8, v60
  v_mfma_f32_16x16x32_bf16 v[68:71], a[192:195], a[228:231], v[68:71]
  s_lshl_b32 s10, s10, 14
  ds_read2_b32 a[130:131], v116 offset0:146 offset1:147
  s_add_u32 m0, s96, 65536
  v_mfma_f32_16x16x32_bf16 v[68:71], a[196:199], a[224:227], v[68:71]
  s_waitcnt lgkmcnt(11)
  ds_read_b128 a[160:163], v115 offset:64
  s_lshl_b32 s12, s99, 7
  s_lshl_b32 s4, s6, 11
  v_mfma_f32_16x16x32_bf16 v[72:75], a[192:195], a[232:235], v[72:75]
  ds_read2_b32 a[132:133], v116 offset0:16 offset1:17
  v_mfma_f32_16x16x32_bf16 v[72:75], a[196:199], a[228:231], v[72:75]
  s_add_u32 s10, s10, s12
  s_add_u32 s78, s87, 0
  v_mfma_f32_16x16x32_bf16 v[72:75], a[200:203], a[224:227], v[72:75]
  s_waitcnt lgkmcnt(10)
  ds_read2_b32 a[134:135], v116 offset0:18 offset1:19
  s_add_u32 s10, s10, s81
  s_nop 0
  s_add_u32 s4, s4, 131072
  v_mfma_f32_16x16x32_bf16 v[76:79], a[192:195], a[236:239], v[76:79]
  s_add_u32 s84, s10, 12582912
  ds_read_b128 a[164:167], v115 offset:576
  buffer_load_dwordx4 v20, s[40:43], s78 offen offset:0  lds
  v_mfma_f32_16x16x32_bf16 v[76:79], a[196:199], a[232:235], v[76:79]
  s_add_u32 s85, s10, 12587008
  ds_read2_b32 a[136:137], v117 offset0:144 offset1:145
  v_add_u32 v110, s4, v110
  v_mfma_f32_16x16x32_bf16 v[76:79], a[200:203], a[228:231], v[76:79]
  ds_read2_b32 a[138:139], v117 offset0:146 offset1:147
  v_mfma_f32_16x16x32_bf16 v[76:79], a[204:207], a[224:227], v[76:79]
  s_waitcnt lgkmcnt(8)
  ds_read_b128 a[168:171], v115 offset:1088
  s_bfe_u32 s10, s3, 0x50002
  buffer_load_dwordx4 v21, s[40:43], s78 offen offset:1024  lds
  v_lshlrev_b32 v60, 3, v63
  v_mfma_f32_16x16x32_bf16 v[32:35], a[148:151], v[120:123], 0
  s_lshl1_add_u32 s10, s10, s92
  ds_read2_b32 a[140:141], v117 offset0:16 offset1:17
  v_mfma_f32_16x16x32_bf16 v[36:39], a[148:151], v[124:127], 0
  s_lshl1_add_u32 s10, s10, s94
  ds_read2_b32 a[142:143], v117 offset0:18 offset1:19
  v_add_u32 v112, 131072, v60
  v_mfma_f32_16x16x32_bf16 v[40:43], a[152:155], v[120:123], 0
  ds_read_b128 a[172:175], v115 offset:1600
  buffer_load_dwordx4 v22, s[40:43], s78 offen offset:2048  lds
  v_mfma_f32_16x16x32_bf16 v[44:47], a[152:155], v[124:127], 0
  s_waitcnt lgkmcnt(15)
  s_lshl2_add_u32 s10, s10, s11
  v_add_u32 v111, s4, v60
  v_mfma_f32_16x16x32_bf16 v[80:83], a[192:195], a[240:243], v[80:83]
  s_lshl_b32 s10, s10, 12
  ds_read_b128 a[176:179], v115 offset:2112
  v_mfma_f32_16x16x32_bf16 v[80:83], a[196:199], a[236:239], v[80:83]
  s_add_u32 s10, s10, s81
  ds_read_b128 a[180:183], v115 offset:2624
  buffer_load_dwordx4 v23, s[40:43], s78 offen offset:3072  lds
  v_lshl_add_u32 v111, v61, 2, v111
  v_mfma_f32_16x16x32_bf16 v[80:83], a[200:203], a[232:235], v[80:83]
  s_add_u32 s75, s10, 12582912
  ds_read_b128 a[184:187], v115 offset:3136
  v_mfma_f32_16x16x32_bf16 v[80:83], a[204:207], a[228:231], v[80:83]
  s_waitcnt lgkmcnt(15)
  ds_read_b128 a[188:191], v115 offset:3648
  s_add_u32 m0, s96, 69632
  v_mfma_f32_16x16x32_bf16 v[84:87], a[192:195], a[244:247], v[84:87]
  s_and_b32 s10, s93, 7
  ds_read2_b32 a[208:209], v119 offset0:48 offset1:49
  v_lshlrev_b32 v113, 4, v63
  v_mfma_f32_16x16x32_bf16 v[84:87], a[196:199], a[240:243], v[84:87]
  s_lshl_b32 s10, s10, 21
  ds_read2_b32 a[210:211], v119 offset0:50 offset1:51
  v_mfma_f32_16x16x32_bf16 v[84:87], a[200:203], a[236:239], v[84:87]
  s_lshl_b32 s11, s93, 13
  ds_read2_b32 a[212:213], v119 offset0:32 offset1:33
  s_add_u32 s78, s87, 57344
  v_cvt_pk_bf16_f32 v48, v32, v36
  v_lshl_add_u32 v113, v62, 9, v113
  v_mfma_f32_16x16x32_bf16 v[84:87], a[204:207], a[232:235], v[84:87]
  s_waitcnt lgkmcnt(15)
  ds_read2_b32 a[214:215], v119 offset0:34 offset1:35
  s_xor_b32 s11, s11, s81
  v_cvt_pk_bf16_f32 v49, v33, v37
  v_mfma_f32_16x16x32_bf16 v[88:91], a[192:195], a[248:251], v[88:91]
  s_lshl_b32 s4, s6, 4
  v_cvt_pk_bf16_f32 v50, v34, v38
  v_mfma_f32_16x16x32_bf16 v[88:91], a[196:199], a[244:247], v[88:91]
  s_and_b32 s11, s11, 8192
  ds_read2_b32 a[216:217], v119 offset0:16 offset1:17
  buffer_load_dwordx4 v20, s[40:43], s78 offen offset:0  lds
  v_cvt_pk_bf16_f32 v51, v35, v39
  v_mfma_f32_16x16x32_bf16 v[88:91], a[200:203], a[240:243], v[88:91]
  s_add_u32 s10, s10, s11
  ds_read2_b32 a[218:219], v119 offset0:18 offset1:19
  v_cvt_pk_bf16_f32 v52, v40, v44
  v_add_u32 v60, s4, v62
  v_mfma_f32_16x16x32_bf16 v[88:91], a[204:207], a[236:239], v[88:91]
  s_waitcnt lgkmcnt(15)
  ds_read2_b32 a[220:221], v119 offset0:0 offset1:1
  s_lshl2_add_u32 s11, s91, s99
  v_cvt_pk_bf16_f32 v53, v41, v45
  v_mfma_f32_16x16x32_bf16 v[92:95], a[192:195], a[252:255], v[92:95]
  s_lshl3_add_u32 s11, s11, s6
  s_nop 0
  ds_read2_b32 a[222:223], v119 offset0:2 offset1:3
  s_mov_b32 s76, 323968
  buffer_load_dwordx4 v21, s[40:43], s78 offen offset:1024  lds
  s_andn2_b32 s4, 8192, s77
  v_cvt_pk_bf16_f32 v54, v42, v46
  v_mfma_f32_16x16x32_bf16 v[92:95], a[196:199], a[248:251], v[92:95]
  buffer_load_dword v57, off, s[36:39], s76 sc1
  v_cvt_pk_bf16_f32 v55, v43, v47
  v_mfma_f32_16x16x32_bf16 v[92:95], a[200:203], a[244:247], v[92:95]
  s_lshl_b32 s11, s11, 11
  buffer_load_dwordx4 v22, s[40:43], s78 offen offset:2048  lds
  v_mfma_f32_16x16x32_bf16 v[92:95], a[204:207], a[240:243], v[92:95]
  s_waitcnt lgkmcnt(15)
  s_add_u32 s11, s11, s10
  v_lshl_add_u32 v107, v63, 2, s4
  v_mfma_f32_16x16x32_bf16 v[64:67], a[128:131], a[160:163], v[64:67]
  s_waitcnt lgkmcnt(15)
  ds_read2_b32 a[192:193], v116 offset0:128 offset1:129
  s_add_u32 s72, s11, 16777216
  v_mfma_f32_16x16x32_bf16 v[68:71], a[128:131], a[164:167], v[68:71]
  s_mul_i32 s11, s91, 327680
  buffer_load_dwordx4 v23, s[40:43], s78 offen offset:3072  lds
  v_lshl_add_u32 v107, v62, 16, v107
L_hop29:
  s_cbranch_execz L_wx
  v_mfma_f32_16x16x32_bf16 v[68:71], a[132:135], a[160:163], v[68:71]
  s_waitcnt lgkmcnt(15)
  ds_read2_b32 a[194:195], v116 offset0:130 offset1:131
  v_mfma_f32_16x16x32_bf16 v[72:75], a[128:131], a[168:171], v[72:75]
  s_add_u32 s10, s10, s11
  s_lshl_b32 s4, s3, 13
  v_mfma_f32_16x16x32_bf16 v[72:75], a[132:135], a[164:167], v[72:75]
  s_add_u32 s10, s10, 17825792
  ds_read_b128 a[224:227], v115 offset:0
  s_add_u32 m0, s96, 73728
  v_mfma_f32_16x16x32_bf16 v[72:75], a[136:139], a[160:163], v[72:75]
  s_waitcnt lgkmcnt(15)
  s_lshl3_add_u32 s11, s99, s6
  v_lshl_add_u32 v108, v60, 4, s4
  v_mfma_f32_16x16x32_bf16 v[76:79], a[128:131], a[172:175], v[76:79]
  ds_read2_b32 a[196:197], v116 offset0:0 offset1:1
  v_mfma_f32_16x16x32_bf16 v[76:79], a[132:135], a[168:171], v[76:79]
  s_lshl_b32 s11, s11, 11
  ds_read2_b32 a[198:199], v116 offset0:2 offset1:3
  s_add_u32 s78, s87, 114688
  v_lshl_add_u32 v108, v63, 10, v108
  v_mfma_f32_16x16x32_bf16 v[76:79], a[136:139], a[164:167], v[76:79]
  s_add_u32 s74, s10, s11
  v_mfma_f32_16x16x32_bf16 v[76:79], a[140:143], a[160:163], v[76:79]
  s_waitcnt lgkmcnt(5)
  ds_read_b128 a[228:231], v115 offset:512
  s_lshl_b32 s71, s6, 12
  buffer_load_dwordx4 v20, s[40:43], s78 offen offset:0  lds
  s_lshl2_add_u32 s5, s99, s6
  v_mfma_f32_16x16x32_bf16 v[80:83], v[48:51], a[208:211], v[80:83]
  s_waitcnt lgkmcnt(15)
  s_min_u32 s71, s71, 10240
  v_mfma_f32_16x16x32_bf16 v[80:83], a[128:131], a[176:179], v[80:83]
  ds_read2_b32 a[200:201], v117 offset0:128 offset1:129
  v_mfma_f32_16x16x32_bf16 v[80:83], a[132:135], a[172:175], v[80:83]
  s_and_b32 s11, s71, 8192
  buffer_load_dwordx4 v21, s[40:43], s78 offen offset:1024  lds
  s_mul_i32 s4, s91, 14
  v_mfma_f32_16x16x32_bf16 v[80:83], a[136:139], a[168:171], v[80:83]
  s_add_u32 s11, s11, s71
  ds_read2_b32 a[202:203], v117 offset0:130 offset1:131
  v_mfma_f32_16x16x32_bf16 v[80:83], a[140:143], a[164:167], v[80:83]
  s_add_u32 s70, s10, s11
  ds_read_b128 a[232:235], v115 offset:1024
  s_add_u32 s4, s4, s5
  v_mfma_f32_16x16x32_bf16 v[84:87], v[48:51], a[212:215], v[84:87]
  s_waitcnt lgkmcnt(15)
  s_lshl2_add_u32 s11, s99, s6
  buffer_load_dwordx4 v22, s[40:43], s78 offen offset:2048  lds
  v_mfma_f32_16x16x32_bf16 v[84:87], a[128:131], a[180:183], v[84:87]
  s_min_u32 s4, s4, 55
  ds_read2_b32 a[204:205], v117 offset0:0 offset1:1
  v_mfma_f32_16x16x32_bf16 v[84:87], a[132:135], a[176:179], v[84:87]
  s_and_b32 s12, s11, 8
  v_mfma_f32_16x16x32_bf16 v[84:87], a[136:139], a[172:175], v[84:87]
  s_add_u32 s12, s12, s11
  ds_read2_b32 a[206:207], v117 offset0:2 offset1:3
  buffer_load_dwordx4 v23, s[40:43], s78 offen offset:3072  lds
  s_lshl_b32 s4, s4, 6
  v_mfma_f32_16x16x32_bf16 v[84:87], a[140:143], a[168:171], v[84:87]
  v_mfma_f32_16x16x32_bf16 v[88:91], v[48:51], a[216:219], v[88:91]
  s_cmp_ge_u32 s11, 14
  s_cselect_b32 s11, 0x100000, s12
  ds_read_b128 a[236:239], v115 offset:1536
  s_add_u32 m0, s96, 77824
  v_and_b32 v25, 31, v1
  v_mfma_f32_16x16x32_bf16 v[88:91], v[52:55], a[208:211], v[88:91]
  s_waitcnt lgkmcnt(15)
  ds_read_b128 a[240:243], v115 offset:2048
  v_mfma_f32_16x16x32_bf16 v[88:91], a[128:131], a[184:187], v[88:91]
  s_lshl_b32 s11, s11, 10
  v_lshl_add_u32 v24, v25, 1, s4
  v_mfma_f32_16x16x32_bf16 v[88:91], a[132:135], a[180:183], v[88:91]
  s_add_u32 s68, s10, s11
  ds_read_b128 a[244:247], v115 offset:2560
  s_add_u32 s78, s87, 172032
  v_mfma_f32_16x16x32_bf16 v[88:91], a[136:139], a[176:179], v[88:91]
  s_mov_b32 s90, 0
  global_load_ushort a112, v24, s[26:27]
  v_mfma_f32_16x16x32_bf16 v[88:91], a[140:143], a[172:175], v[88:91]
  s_mov_b32 s49, 0x46000000
  ds_read_b128 a[248:251], v115 offset:3072
  v_mfma_f32_16x16x32_bf16 v[92:95], v[48:51], a[220:223], v[92:95]
  buffer_load_dwordx4 v20, s[40:43], s78 offen offset:0  lds
  global_load_dwordx4 v[120:123], v108, s[8:9]
  v_mfma_f32_16x16x32_bf16 v[92:95], v[52:55], a[212:215], v[92:95]
  s_waitcnt lgkmcnt(15)
  ds_read_b128 a[252:255], v115 offset:3584
  s_mov_b32 s50, 0x2d000000
  v_mfma_f32_16x16x32_bf16 v[92:95], a[128:131], a[188:191], v[92:95]
  s_mov_b32 s51, 0xc6888e99
  global_load_dwordx4 v[124:127], v108, s[8:9] offset:128
  v_mfma_f32_16x16x32_bf16 v[92:95], a[132:135], a[184:187], v[92:95]
  buffer_load_dwordx4 v21, s[40:43], s78 offen offset:1024  lds
  v_mfma_f32_16x16x32_bf16 v[92:95], a[136:139], a[180:183], v[92:95]
  v_mfma_f32_16x16x32_bf16 v[92:95], a[140:143], a[176:179], v[92:95]
  s_waitcnt lgkmcnt(0)
  s_barrier
  s_bitcmp1_b32 s48, 30
  s_cselect_b32 s49, 0x26000000, s49
  s_cselect_b32 s50, 0x4d000000, s50
  s_cselect_b32 s51, 0xa6888e99, s51
  buffer_load_dwordx4 v22, s[40:43], s78 offen offset:2048  lds
  v_mfma_f32_16x16x32_bf16 v[64:67], a[192:195], a[224:227], v[64:67]
  v_mfma_f32_16x16x32_bf16 v[68:71], a[192:195], a[228:231], v[68:71]
  v_mfma_f32_16x16x32_bf16 v[68:71], a[196:199], a[224:227], v[68:71]
  s_sub_u32 s34, 0x7f000000, s49
  buffer_load_dwordx4 v23, s[40:43], s78 offen offset:3072  lds
  v_mfma_f32_16x16x32_bf16 v[72:75], a[192:195], a[232:235], v[72:75]
  v_mfma_f32_16x16x32_bf16 v[72:75], a[196:199], a[228:231], v[72:75]
  s_mov_b32 s35, s50
  v_mfma_f32_16x16x32_bf16 v[72:75], a[200:203], a[224:227], v[72:75]
  s_lshr_b32 s80, s49, 16
  v_mfma_f32_16x16x32_bf16 v[76:79], a[192:195], a[236:239], v[76:79]
  s_waitcnt vmcnt(13)
  ds_write_b128 v109, v[64:67] offset:0
  v_readfirstlane_b32 s76, v57
  v_mfma_f32_16x16x32_bf16 v[76:79], a[196:199], a[232:235], v[76:79]
  v_mfma_f32_16x16x32_bf16 v[76:79], a[200:203], a[228:231], v[76:79]
  s_sub_u32 s76, s76, s54
  ds_write_b128 v109, v[68:71] offset:1024
  v_mfma_f32_16x16x32_bf16 v[76:79], a[204:207], a[224:227], v[76:79]
  v_mfma_f32_16x16x32_bf16 v[80:83], a[192:195], a[240:243], v[80:83]
  s_cmp_gt_u32 s76, 1
  s_cbranch_scc1 L_decretry
L_decok:
  v_mfma_f32_16x16x32_bf16 v[80:83], a[196:199], a[236:239], v[80:83]
  s_and_b32 s76, s76, 1
  ds_write_b128 v109, v[72:75] offset:2048
  v_mfma_f32_16x16x32_bf16 v[80:83], a[200:203], a[232:235], v[80:83]
  s_lshl_b32 s76, s76, 13
  v_mfma_f32_16x16x32_bf16 v[80:83], a[204:207], a[228:231], v[80:83]
  s_xor_b32 s83, s83, s76
  v_mfma_f32_16x16x32_bf16 v[84:87], a[192:195], a[244:247], v[84:87]
  s_xor_b32 s84, s84, s76
  v_mfma_f32_16x16x32_bf16 v[84:87], a[196:199], a[240:243], v[84:87]
  s_xor_b32 s85, s85, s76
  ds_write_b128 v109, v[76:79] offset:3072
  v_mfma_f32_16x16x32_bf16 v[84:87], a[200:203], a[236:239], v[84:87]
  v_mfma_f32_16x16x32_bf16 v[84:87], a[204:207], a[232:235], v[84:87]
  s_xor_b32 s75, s75, s76
  v_mfma_f32_16x16x32_bf16 v[88:91], a[192:195], a[248:251], v[88:91]
  s_xor_b32 s72, s72, s76
  v_mfma_f32_16x16x32_bf16 v[88:91], a[196:199], a[244:247], v[88:91]
  s_xor_b32 s70, s70, s76
  ds_write_b128 v109, v[80:83] offset:4096
  v_mfma_f32_16x16x32_bf16 v[88:91], a[200:203], a[240:243], v[88:91]
  s_xor_b32 s68, s68, s76
  v_mfma_f32_16x16x32_bf16 v[88:91], a[204:207], a[236:239], v[88:91]
  s_xor_b32 s74, s74, s76
  v_mfma_f32_16x16x32_bf16 v[92:95], a[192:195], a[252:255], v[92:95]
  s_xor_b32 s13, s13, s76
  v_mfma_f32_16x16x32_bf16 v[92:95], a[196:199], a[248:251], v[92:95]
  ds_write_b128 v109, v[84:87] offset:5120
  v_xor_b32 v107, s76, v107
  v_mfma_f32_16x16x32_bf16 v[92:95], a[200:203], a[244:247], v[92:95]
  v_mfma_f32_16x16x32_bf16 v[92:95], a[204:207], a[240:243], v[92:95]
  ds_write_b128 v109, v[88:91] offset:6144
  s_nop 6
  ds_write_b128 v109, v[92:95] offset:7168
  s_waitcnt vmcnt(20)
  s_waitcnt lgkmcnt(0)
  s_barrier
  s_nop 0
  ds_read_b128 v[64:67], v110 offset:0
  ds_read_b128 v[68:71], v110 offset:8192
  ds_read_b128 v[72:75], v110 offset:16384
  ds_read_b128 v[76:79], v110 offset:24576
  ds_read_b128 v[80:83], v110 offset:1024
  ds_read_b128 v[84:87], v110 offset:9216
  ds_read_b128 v[88:91], v110 offset:17408
  ds_read_b128 v[92:95], v110 offset:25600
  s_waitcnt lgkmcnt(4)
  s_nop 0
  v_pk_add_f32 v[64:65], v[64:65], v[68:69]
  v_pk_add_f32 v[66:67], v[66:67], v[70:71]
  v_pk_add_f32 v[72:73], v[72:73], v[76:77]
  v_pk_add_f32 v[74:75], v[74:75], v[78:79]
  v_pk_fma_f32 v[64:65], v[64:65], s[34:35], s[34:35] op_sel:[0,0,1] op_sel_hi:[1,0,1]
  v_pk_fma_f32 v[66:67], v[66:67], s[34:35], s[34:35] op_sel:[0,0,1] op_sel_hi:[1,0,1]
  v_pk_fma_f32 v[72:73], v[72:73], s[34:35], s[34:35] op_sel:[0,0,1] op_sel_hi:[1,0,1]
  v_pk_fma_f32 v[74:75], v[74:75], s[34:35], s[34:35] op_sel:[0,0,1] op_sel_hi:[1,0,1]
  v_cvt_pk_bf16_f32 v48, v64, v72
  v_cvt_pk_bf16_f32 v49, v65, v73
  v_cvt_pk_bf16_f32 v50, v66, v74
  v_cvt_pk_bf16_f32 v51, v67, v75
  buffer_store_dwordx4 v[48:51], v3, s[36:39], s83 offen offset:0 sc1
  s_waitcnt lgkmcnt(0)
  s_nop 0
  v_pk_add_f32 v[80:81], v[80:81], v[84:85]
  v_pk_add_f32 v[82:83], v[82:83], v[86:87]
  v_pk_add_f32 v[88:89], v[88:89], v[92:93]
  v_pk_add_f32 v[90:91], v[90:91], v[94:95]
  v_pk_fma_f32 v[80:81], v[80:81], s[34:35], s[34:35] op_sel:[0,0,1] op_sel_hi:[1,0,1]
  v_pk_fma_f32 v[82:83], v[82:83], s[34:35], s[34:35] op_sel:[0,0,1] op_sel_hi:[1,0,1]
  v_pk_fma_f32 v[88:89], v[88:89], s[34:35], s[34:35] op_sel:[0,0,1] op_sel_hi:[1,0,1]
  v_pk_fma_f32 v[90:91], v[90:91], s[34:35], s[34:35] op_sel:[0,0,1] op_sel_hi:[1,0,1]
  v_cvt_pk_bf16_f32 v52, v80, v88
  v_cvt_pk_bf16_f32 v53, v81, v89
  v_cvt_pk_bf16_f32 v54, v82, v90
  v_cvt_pk_bf16_f32 v55, v83, v91
  buffer_store_dwordx4 v[52:55], v3, s[36:39], s83 offen offset:1024 sc1
  s_waitcnt vmcnt(2)
  s_waitcnt lgkmcnt(0)
  s_barrier
  s_add_u32 m0, s77, 147456
  s_add_u32 s78, s88, 0
  buffer_load_dwordx4 v4, s[44:47], s78 offen offset:0  lds
  buffer_load_dwordx4 v5, s[44:47], s78 offen offset:1024  lds
  buffer_load_dwordx4 v6, s[44:47], s78 offen offset:2048  lds
  buffer_load_dwordx4 v7, s[44:47], s78 offen offset:3072  lds
  ds_read_b64_tr_b16 v[128:129], v9 offset:0
  ds_read_b64_tr_b16 v[130:131], v9 offset:1024
  ds_read_b64_tr_b16 v[132:133], v9 offset:4096
  ds_read_b64_tr_b16 v[134:135], v9 offset:5120
  ds_read_b64_tr_b16 v[136:137], v9 offset:8192
  ds_read_b64_tr_b16 v[138:139], v9 offset:9216
  ds_read_b64_tr_b16 v[140:141], v9 offset:12288
  ds_read_b64_tr_b16 v[142:143], v9 offset:13312
  ds_read_b64_tr_b16 v[144:145], v9 offset:16384
  ds_read_b64_tr_b16 v[146:147], v9 offset:17408
  ds_read_b64_tr_b16 v[148:149], v9 offset:20480
  ds_read_b64_tr_b16 v[150:151], v9 offset:21504
  ds_read_b64_tr_b16 v[152:153], v9 offset:24576
  ds_read_b64_tr_b16 v[154:155], v9 offset:25600
  ds_read_b64_tr_b16 v[156:157], v9 offset:28672
  ds_read_b64_tr_b16 v[158:159], v9 offset:29696
  ds_read_b64_tr_b16 v[160:161], v9 offset:32768
  ds_read_b64_tr_b16 v[162:163], v9 offset:33792
  ds_read_b64_tr_b16 v[164:165], v9 offset:36864
  ds_read_b64_tr_b16 v[166:167], v9 offset:37888
  ds_read_b64_tr_b16 v[168:169], v9 offset:40960
  ds_read_b64_tr_b16 v[170:171], v9 offset:41984
  ds_read_b64_tr_b16 v[172:173], v9 offset:45056
  ds_read_b64_tr_b16 v[174:175], v9 offset:46080
  ds_read_b64_tr_b16 v[176:177], v9 offset:49152
  ds_read_b64_tr_b16 v[178:179], v9 offset:50176
  ds_read_b64_tr_b16 v[180:181], v9 offset:53248
  ds_read_b64_tr_b16 v[182:183], v9 offset:54272
  ds_read_b64_tr_b16 v[184:185], v9 offset:57344
  ds_read_b64_tr_b16 v[186:187], v9 offset:58368
  ds_read_b64_tr_b16 v[188:189], v9 offset:61440
  ds_read_b64_tr_b16 v[190:191], v9 offset:62464
  s_waitcnt lgkmcnt(0)
  s_barrier
  s_add_u32 m0, s77, 0
  s_nop 0
  s_add_u32 s78, s88, 65536
  buffer_load_dwordx4 v4, s[44:47], s78 offen offset:0  lds
  buffer_load_dwordx4 v5, s[44:47], s78 offen offset:1024  lds
  buffer_load_dwordx4 v6, s[44:47], s78 offen offset:2048  lds
  buffer_load_dwordx4 v7, s[44:47], s78 offen offset:3072  lds
  v_add_u32 v9, 0x10000, v9
  ds_read_b64_tr_b16 v[192:193], v9 offset:0
  ds_read_b64_tr_b16 v[194:195], v9 offset:1024
  ds_read_b64_tr_b16 v[196:197], v9 offset:4096
  ds_read_b64_tr_b16 v[198:199], v9 offset:5120
  ds_read_b64_tr_b16 v[200:201], v9 offset:8192
  ds_read_b64_tr_b16 v[202:203], v9 offset:9216
  ds_read_b64_tr_b16 v[204:205], v9 offset:12288
  ds_read_b64_tr_b16 v[206:207], v9 offset:13312
  ds_read_b64_tr_b16 v[208:209], v9 offset:16384
  ds_read_b64_tr_b16 v[210:211], v9 offset:17408
  ds_read_b64_tr_b16 v[212:213], v9 offset:20480
  ds_read_b64_tr_b16 v[214:215], v9 offset:21504
  ds_read_b64_tr_b16 v[216:217], v9 offset:24576
  ds_read_b64_tr_b16 v[218:219], v9 offset:25600
  ds_read_b64_tr_b16 v[220:221], v9 offset:28672
  ds_read_b64_tr_b16 v[222:223], v9 offset:29696
  ds_read_b64_tr_b16 v[224:225], v9 offset:32768
  ds_read_b64_tr_b16 v[226:227], v9 offset:33792
  ds_read_b64_tr_b16 v[228:229], v9 offset:36864
  ds_read_b64_tr_b16 v[230:231], v9 offset:37888
  ds_read_b64_tr_b16 v[232:233], v9 offset:40960
  ds_read_b64_tr_b16 v[234:235], v9 offset:41984
  ds_read_b64_tr_b16 v[236:237], v9 offset:45056
  ds_read_b64_tr_b16 v[238:239], v9 offset:46080
  ds_read_b64_tr_b16 v[240:241], v9 offset:49152
  ds_read_b64_tr_b16 v[242:243], v9 offset:50176
  ds_read_b64_tr_b16 v[244:245], v9 offset:53248
  ds_read_b64_tr_b16 v[246:247], v9 offset:54272
  ds_read_b64_tr_b16 v[248:249], v9 offset:57344
  ds_read_b64_tr_b16 v[250:251], v9 offset:58368
  ds_read_b64_tr_b16 v[252:253], v9 offset:61440
  ds_read_b64_tr_b16 v[254:255], v9 offset:62464
  v_mov_b32 v27, 0x60006000
  v_add_u32 v3, 65536, v2
  v_add_u32 v10, 131072, v2
  v_mov_b32 v11, 0xc0088e99
  v_add_u32 v60, v26, v62
  v_and_b32 v60, 3, v60
  v_lshl_add_u32 v60, v60, 2, v2
  v_add_u32 v8, s77, v60
  v_xor_b32 v60, v62, v19
  v_and_b32 v60, 1, v60
  v_lshl_add_u32 v60, v60, 3, v2
  v_add_u32 v12, s71, v60
  v_add_u32 v13, 0x10000, v12
  v_add_u32 v14, 0x20000, v8
  v_add_u32 v29, 0x10000, v28
  v_add_u32 v15, 0x20000, v28
  s_xor_b32 s7, s91, 3
  s_lshl2_add_u32 s7, s93, s7
  s_lshl2_add_u32 s5, s94, s99
  s_and_b32 s4, s6, 1
  s_lshl1_add_u32 s5, s5, s4
  s_lshl_b32 s4, s5, 6
  v_lshl_add_u32 v24, v26, 5, s4
  s_lshl_b32 s4, s7, 15
  v_lshl_add_u32 v16, v25, 10, v24
  v_add_u32 v16, s4, v16
  s_lshl_b32 s4, s7, 7
  s_and_b32 s101, s4, 0x480
  s_xor_b32 s4, s4, s101
  s_and_b32 s5, s5, 7
  s_lshl_b32 s5, s5, 18
  s_add_u32 s4, s4, s5
  s_lshl_b32 s5, s6, 12
  s_xor_b32 s5, s5, s13
  s_and_b32 s5, s5, 8192
  s_add_u32 s4, s4, s5
  v_lshlrev_b32 v17, 17, v26
  v_lshl_add_u32 v17, v25, 2, v17
  v_add_u32 v17, s4, v17
  s_waitcnt vmcnt(13)
  v_lshlrev_b32 v32, 16, v120
  v_and_b32 v33, 0xffff0000, v120
  v_lshlrev_b32 v34, 16, v121
  v_and_b32 v35, 0xffff0000, v121
  v_lshlrev_b32 v36, 16, v122
  v_and_b32 v37, 0xffff0000, v122
  v_lshlrev_b32 v38, 16, v123
  v_and_b32 v39, 0xffff0000, v123
  v_lshlrev_b32 v40, 16, v124
  v_and_b32 v41, 0xffff0000, v124
  v_lshlrev_b32 v42, 16, v125
  v_and_b32 v43, 0xffff0000, v125
  v_lshlrev_b32 v44, 16, v126
  v_and_b32 v45, 0xffff0000, v126
  v_lshlrev_b32 v46, 16, v127
  v_and_b32 v47, 0xffff0000, v127
  s_mov_b64 exec, 0
  s_cmp_eq_u32 s6, 1
  s_cbranch_scc1 L_hop45
  s_cmp_eq_u32 s6, 2
  s_cbranch_scc1 L_hop61
  s_cmp_eq_u32 s6, 3
  s_cbranch_scc1 L_hop77
L_wb2:
  s_mov_b64 exec, -1
  s_waitcnt vmcnt(8)
  buffer_load_dword v80, v107, s[36:39], s60 offen sc1
  buffer_load_dword v81, v107, s[36:39], s61 offen sc1
  buffer_load_dword v82, v107, s[36:39], s62 offen sc1
  buffer_load_dword v83, v107, s[36:39], s63 offen sc1
  buffer_load_dword v84, v107, s[36:39], s64 offen sc1
  buffer_load_dword v85, v107, s[36:39], s65 offen sc1
  buffer_load_dword v86, v107, s[36:39], s66 offen sc1
  buffer_load_dword v87, v107, s[36:39], s67 offen sc1
  v_mov_b32 v52, 0
  v_mov_b32 v53, 0
  v_mov_b32 v54, 0x4091b003
  s_waitcnt vmcnt(0)
L_h2chk:
  v_bitop3_b32 v60, v80, v81, s48 bitop3:0x7e
  v_bitop3_b32 v61, v82, v83, s48 bitop3:0x7e
  v_bitop3_b32 v62, v84, v85, s48 bitop3:0x7e
  v_bitop3_b32 v63, v86, v87, s48 bitop3:0x7e
  v_or3_b32 v60, v60, v61, v62
  v_bitop3_b32 v60, v60, v63, v27 bitop3:0xa8
  v_cmp_ne_u32 vcc, 0, v60
  v_lshlrev_b32 v64, 16, v80
  v_and_b32 v65, 0xffff0000, v80
  v_lshlrev_b32 v66, 16, v81
  v_and_b32 v67, 0xffff0000, v81
  v_lshlrev_b32 v68, 16, v82
  v_and_b32 v69, 0xffff0000, v82
  v_lshlrev_b32 v70, 16, v83
  v_and_b32 v71, 0xffff0000, v83
  s_cbranch_vccnz L_h2retry
L_h2ok:
  v_lshlrev_b32 v72, 16, v84
  v_and_b32 v73, 0xffff0000, v84
  v_lshlrev_b32 v74, 16, v85
  v_and_b32 v75, 0xffff0000, v85
  v_lshlrev_b32 v76, 16, v86
  v_and_b32 v77, 0xffff0000, v86
  v_lshlrev_b32_e64 v78, 16, v87
  v_and_b32 v79, 0xffff0000, v87
  v_pk_fma_f32 v[64:65], v[64:65], s[48:49], v[32:33] op_sel:[0,1,0] op_sel_hi:[1,1,1]
  v_pk_fma_f32 v[66:67], v[66:67], s[48:49], v[34:35] op_sel:[0,1,0] op_sel_hi:[1,1,1]
  v_pk_fma_f32 v[68:69], v[68:69], s[48:49], v[36:37] op_sel:[0,1,0] op_sel_hi:[1,1,1]
  v_pk_fma_f32 v[70:71], v[70:71], s[48:49], v[38:39] op_sel:[0,1,0] op_sel_hi:[1,1,1]
  v_pk_fma_f32 v[72:73], v[72:73], s[48:49], v[40:41] op_sel:[0,1,0] op_sel_hi:[1,1,1]
  v_pk_fma_f32 v[74:75], v[74:75], s[48:49], v[42:43] op_sel:[0,1,0] op_sel_hi:[1,1,1]
  v_pk_fma_f32 v[76:77], v[76:77], s[48:49], v[44:45] op_sel:[0,1,0] op_sel_hi:[1,1,1]
  v_pk_fma_f32 v[78:79], v[78:79], s[48:49], v[46:47] op_sel:[0,1,0] op_sel_hi:[1,1,1]
  v_cvt_pk_bf16_f32 v40, v64, v65
  v_cvt_pk_bf16_f32 v41, v66, v67
  v_cvt_pk_bf16_f32 v42, v68, v69
  v_cvt_pk_bf16_f32 v43, v70, v71
  v_cvt_pk_bf16_f32 v44, v72, v73
  v_cvt_pk_bf16_f32 v45, v74, v75
  v_cvt_pk_bf16_f32 v46, v76, v77
  v_cvt_pk_bf16_f32 v47, v78, v79
  v_dot2c_f32_bf16 v52, s55, v40
  v_dot2c_f32_bf16 v53, v40, v40
  v_dot2c_f32_bf16 v52, s55, v41
  v_dot2c_f32_bf16 v53, v41, v41
  v_dot2c_f32_bf16 v52, s55, v42
  v_dot2c_f32_bf16 v53, v42, v42
  v_dot2c_f32_bf16 v52, s55, v43
  v_dot2c_f32_bf16 v53, v43, v43
  v_dot2c_f32_bf16 v52, s55, v44
  v_dot2c_f32_bf16 v53, v44, v44
  v_dot2c_f32_bf16 v52, s55, v45
  v_dot2c_f32_bf16 v53, v45, v45
  v_dot2c_f32_bf16 v52, s55, v46
  v_dot2c_f32_bf16 v53, v46, v46
  v_dot2c_f32_bf16 v52, s55, v47
  v_dot2c_f32_bf16 v53, v47, v47
  v_lshlrev_b32 v64, 16, v40
  v_and_b32 v65, 0xffff0000, v40
  v_add_f32 v52, v52, v52 row_ror:8
  v_add_f32 v53, v53, v53 row_ror:8
  v_lshlrev_b32 v66, 16, v41
  v_and_b32 v67, 0xffff0000, v41
  v_permlane16_swap_b32 v52, v53
  v_add_f32 v52, v52, v53
  v_mov_b32 v53, v52
  v_lshlrev_b32 v68, 16, v42
  v_and_b32 v69, 0xffff0000, v42
  v_permlane32_swap_b32 v52, v53
  v_add_f32 v52, v52, v53
  ds_write_b32 v111, v52
  s_add_u32 m0, s77, 16384
  s_add_u32 s78, s88, 131072
  buffer_load_dwordx4 v4, s[44:47], s78 offen offset:0  lds
  buffer_load_dwordx4 v5, s[44:47], s78 offen offset:1024  lds
  buffer_load_dwordx4 v6, s[44:47], s78 offen offset:2048  lds
  buffer_load_dwordx4 v7, s[44:47], s78 offen offset:3072  lds
  v_lshlrev_b32 v70, 16, v43
  v_and_b32 v71, 0xffff0000, v43
  v_lshlrev_b32 v72, 16, v44
  v_and_b32 v73, 0xffff0000, v44
  s_waitcnt lgkmcnt(0)
  s_barrier
  ds_read2st64_b64 v[32:35], v112 offset0:0 offset1:4
  ds_read2st64_b64 v[36:39], v112 offset0:8 offset1:12
  s_mov_b32 s4, 0x3b000000
  v_lshlrev_b32 v74, 16, v45
  v_and_b32 v75, 0xffff0000, v45
  v_lshlrev_b32 v76, 16, v46
  v_and_b32 v77, 0xffff0000, v46
  v_lshlrev_b32 v78, 16, v47
  v_and_b32 v79, 0xffff0000, v47
  s_waitcnt lgkmcnt(0)
  v_pk_add_f32 v[32:33], v[32:33], v[34:35]
  v_pk_add_f32 v[36:37], v[36:37], v[38:39]
  v_pk_add_f32 v[32:33], v[32:33], v[36:37]
  v_pk_mul_f32 v[32:33], v[32:33], s[4:5] op_sel_hi:[1,0]
  v_fma_f32 v33, -v32, v32, v33
  v_max_f32 v33, 0, v33
  v_fmaak_f32 v33, v33, v54, 0x2ffa496c
  v_rsq_f32 v34, v33
  s_nop 0
  v_mul_f32 v35, v32, v34
  v_pk_fma_f32 v[64:65], v[64:65], v[34:35], v[34:35] op_sel:[0,0,1] op_sel_hi:[1,0,1] neg_lo:[0,1,0] neg_hi:[0,1,0]
  v_pk_fma_f32 v[66:67], v[66:67], v[34:35], v[34:35] op_sel:[0,0,1] op_sel_hi:[1,0,1] neg_lo:[0,1,0] neg_hi:[0,1,0]
  v_pk_fma_f32 v[68:69], v[68:69], v[34:35], v[34:35] op_sel:[0,0,1] op_sel_hi:[1,0,1] neg_lo:[0,1,0] neg_hi:[0,1,0]
  v_pk_fma_f32 v[70:71], v[70:71], v[34:35], v[34:35] op_sel:[0,0,1] op_sel_hi:[1,0,1] neg_lo:[0,1,0] neg_hi:[0,1,0]
  v_cvt_pk_bf16_f32 v48, v64, v65
  v_cvt_pk_bf16_f32 v49, v66, v67
  v_cvt_pk_bf16_f32 v50, v68, v69
  v_cvt_pk_bf16_f32 v51, v70, v71
  buffer_store_dwordx4 v[48:51], v113, s[36:39], s84 offen sc1
  v_pk_fma_f32 v[72:73], v[72:73], v[34:35], v[34:35] op_sel:[0,0,1] op_sel_hi:[1,0,1] neg_lo:[0,1,0] neg_hi:[0,1,0]
  v_pk_fma_f32 v[74:75], v[74:75], v[34:35], v[34:35] op_sel:[0,0,1] op_sel_hi:[1,0,1] neg_lo:[0,1,0] neg_hi:[0,1,0]
  v_pk_fma_f32 v[76:77], v[76:77], v[34:35], v[34:35] op_sel:[0,0,1] op_sel_hi:[1,0,1] neg_lo:[0,1,0] neg_hi:[0,1,0]
  v_pk_fma_f32 v[78:79], v[78:79], v[34:35], v[34:35] op_sel:[0,0,1] op_sel_hi:[1,0,1] neg_lo:[0,1,0] neg_hi:[0,1,0]
  v_cvt_pk_bf16_f32 v52, v72, v73
  v_cvt_pk_bf16_f32 v53, v74, v75
  v_cvt_pk_bf16_f32 v54, v76, v77
  v_cvt_pk_bf16_f32 v55, v78, v79
  buffer_store_dwordx4 v[52:55], v113, s[36:39], s85 offen sc1
  ds_read_b64_tr_b16 a[0:1], v15 offset:16384
  ds_read_b64_tr_b16 a[2:3], v15 offset:18432
  ds_read_b64_tr_b16 a[4:5], v15 offset:20480
  ds_read_b64_tr_b16 a[6:7], v15 offset:22528
  ds_read_b64_tr_b16 a[8:9], v15 offset:24576
  ds_read_b64_tr_b16 a[10:11], v15 offset:26624
  ds_read_b64_tr_b16 a[12:13], v15 offset:28672
  ds_read_b64_tr_b16 a[14:15], v15 offset:30720
  ds_read_b64_tr_b16 a[16:17], v28 offset:0
  ds_read_b64_tr_b16 a[18:19], v28 offset:2048
  ds_read_b64_tr_b16 a[20:21], v28 offset:4096
  ds_read_b64_tr_b16 a[22:23], v28 offset:6144
  ds_read_b64_tr_b16 a[24:25], v28 offset:8192
  ds_read_b64_tr_b16 a[26:27], v28 offset:10240
  ds_read_b64_tr_b16 a[28:29], v28 offset:12288
  ds_read_b64_tr_b16 a[30:31], v28 offset:14336
  v_accvgpr_read_b32 v32, a112
  v_mov_b32 v33, 0
  v_mov_b32 v34, 0
  v_mov_b32 v35, 0
  v_lshl_or_b32 v32, v32, 16, v32
  v_cmp_gt_u32 vcc, 32, v1
  v_mov_b32 v36, 0x38abbef0
  v_mov_b32 v37, 0
  v_mov_b32 v38, 0
  v_mov_b32 v39, 0
  v_cndmask_b32 v36, 0, v36, vcc
  s_mov_b32 s90, 0
  s_mov_b32 s10, 0x409d30fc
  v_mfma_f32_32x32x16_bf16 v[112:127], v[32:35], v[36:39], 0
  s_xor_b32 s56, s48, 0x20002000
  s_mov_b32 s57, 0x06000000
  s_mov_b32 s58, 0x6d000000
  s_mov_b32 s4, 0x99088e99
  s_bitcmp1_b32 s48, 30
  s_cselect_b32 s57, 0x65800000, s57
  s_cselect_b32 s58, 0x0d800000, s58
  s_cselect_b32 s4, 0xd8888e99, s4
  s_lshr_b32 s59, s58, 16
  v_mov_b32 v30, s4
  v_mov_b32 v44, s48
  v_mov_b32 v45, s48
  v_mov_b32 v46, s48
  v_mov_b32 v47, s48
  s_and_b32 s4, s74, 0x5800
  s_cmp_eq_u32 s4, 0x5800
  s_cselect_b32 s100, s74, 33554432
  v_add_u32 v9, 0x10000, v8
  s_sub_u32 s4, 0, s77
  v_add_u32 v59, s4, v8
  s_xor_b32 s60, s101, 6291456
  s_xor_b32 s61, s101, 6307840
  s_xor_b32 s62, s101, 6324224
  s_xor_b32 s63, s101, 6340608
  s_xor_b32 s64, s101, 6356992
  s_xor_b32 s65, s101, 6373376
  s_xor_b32 s66, s101, 6389760
  s_xor_b32 s67, s101, 6406144
  s_lshl2_add_u32 s4, s99, s6
  s_cmp_ge_u32 s4, 14
  s_cselect_b32 s4, -1024, -1
  v_and_b32 v56, s4, v2
  v_and_b32 v57, s4, v3
  v_and_b32 v58, s4, v10
  s_waitcnt vmcnt(0)
  s_add_u32 m0, s77, 32768
  s_xor_b32 s78, s75, 0
  s_nop 0
  buffer_load_dwordx4 v2, s[36:39], s78 offen offset:0 sc1 lds
  buffer_load_dwordx4 v2, s[36:39], s78 offen offset:1024 sc1 lds
  buffer_load_dwordx4 v2, s[36:39], s78 offen offset:2048 sc1 lds
  buffer_load_dwordx4 v2, s[36:39], s78 offen offset:3072 sc1 lds
  s_add_u32 m0, s77, 49152
  s_xor_b32 s78, s75, 32768
  buffer_load_dwordx4 v2, s[36:39], s78 offen offset:0 sc1 lds
  buffer_load_dwordx4 v2, s[36:39], s78 offen offset:1024 sc1 lds
  buffer_load_dwordx4 v2, s[36:39], s78 offen offset:2048 sc1 lds
  buffer_load_dwordx4 v2, s[36:39], s78 offen offset:3072 sc1 lds
  s_add_u32 m0, s77, 65536
  s_xor_b32 s78, s75, 65536
  buffer_load_dwordx4 v2, s[36:39], s78 offen offset:0 sc1 lds
  buffer_load_dwordx4 v2, s[36:39], s78 offen offset:1024 sc1 lds
  buffer_load_dwordx4 v2, s[36:39], s78 offen offset:2048 sc1 lds
  buffer_load_dwordx4 v2, s[36:39], s78 offen offset:3072 sc1 lds
  s_waitcnt vmcnt(8)
  ds_read2st64_b32 v[48:49], v8 offset0:128 offset1:132
  ds_read2st64_b32 v[50:51], v8 offset0:136 offset1:140
  s_waitcnt lgkmcnt(0)
  v_max3_f32 v48, abs(v48), abs(v49), abs(v50)
  v_max_f32_e64 v48, v48, abs(v51)
  v_cmp_le_f32 vcc, 0x60000000, v48
  s_cbranch_vccnz L_x0retry
L_x0ok:
  s_barrier
  ds_read_b128 a[224:227], v56 offset:32768
  ds_read_b128 a[228:231], v56 offset:33792
  ds_read_b128 a[232:235], v56 offset:34816
  ds_read_b128 a[236:239], v56 offset:35840
  ds_read_b128 a[240:243], v56 offset:36864
  s_waitcnt lgkmcnt(4)
  v_mfma_f32_32x32x16_bf16 v[64:79], v[128:131], a[224:227], v[112:127]
  s_waitcnt lgkmcnt(3)
  ds_read_b128 a[244:247], v56 offset:37888
  s_add_u32 m0, s77, 0
  s_xor_b32 s78, s75, 98304
  ds_read_b64_tr_b16 a[32:33], v28 offset:16384
  v_mfma_f32_32x32x16_bf16 v[64:79], v[132:135], a[228:231], v[64:79]
  s_waitcnt lgkmcnt(3)
  ds_read_b128 a[248:251], v56 offset:38912
  buffer_load_dwordx4 v2, s[36:39], s78 offen offset:0 sc1 lds
  ds_read_b64_tr_b16 a[34:35], v28 offset:18432
  ds_read_b64_tr_b16 a[36:37], v28 offset:20480
  v_mfma_f32_32x32x16_bf16 v[64:79], v[136:139], a[232:235], v[64:79]
  s_waitcnt vmcnt(5)
  ds_read_b128 a[252:255], v56 offset:39936
  ds_read2st64_b32 v[48:49], v8 offset0:192 offset1:196
  buffer_load_dwordx4 v2, s[36:39], s78 offen offset:1024 sc1 lds
  buffer_load_dwordx4 v2, s[36:39], s78 offen offset:2048 sc1 lds
  ds_read_b64_tr_b16 a[38:39], v28 offset:22528
  v_mfma_f32_32x32x16_bf16 v[64:79], v[140:143], a[236:239], v[64:79]
  s_waitcnt lgkmcnt(8)
  ds_read_b128 a[224:227], v56 offset:40960
  ds_read2st64_b32 v[50:51], v8 offset0:200 offset1:204
  buffer_load_dwordx4 v2, s[36:39], s78 offen offset:3072 sc1 lds
  ds_read_b64_tr_b16 a[40:41], v28 offset:24576
  v_mfma_f32_32x32x16_bf16 v[64:79], v[144:147], a[240:243], v[64:79]
  s_waitcnt lgkmcnt(8)
  s_nop 0
  ds_read_b128 a[228:231], v56 offset:41984
L_hop45:
  s_cbranch_execz L_wb2
  s_nop 0
  ds_read_b64_tr_b16 a[42:43], v28 offset:26624
  ds_read_b64_tr_b16 a[44:45], v28 offset:28672
  v_mfma_f32_32x32x16_bf16 v[64:79], v[148:151], a[244:247], v[64:79]
  s_add_u32 m0, s77, 81920
  ds_read_b128 a[232:235], v56 offset:43008
  s_xor_b32 s78, s75, 131072
  ds_read_b64_tr_b16 a[46:47], v28 offset:30720
  v_mfma_f32_32x32x16_bf16 v[64:79], v[152:155], a[248:251], v[64:79]
  s_waitcnt lgkmcnt(7)
  ds_read_b128 a[236:239], v56 offset:44032
  buffer_load_dwordx4 v2, s[36:39], s78 offen offset:0 sc1 lds
  v_mfma_f32_32x32x16_bf16 v[64:79], v[156:159], a[252:255], v[64:79]
  s_waitcnt lgkmcnt(7)
  ds_read_b128 a[240:243], v56 offset:45056
  buffer_load_dwordx4 v2, s[36:39], s78 offen offset:1024 sc1 lds
  buffer_load_dwordx4 v2, s[36:39], s78 offen offset:2048 sc1 lds
  v_max3_f32 v48, abs(v48), abs(v49), abs(v50)
  v_mfma_f32_32x32x16_bf16 v[64:79], v[160:163], a[224:227], v[64:79]
  s_waitcnt lgkmcnt(6)
  ds_read_b128 a[244:247], v56 offset:46080
  buffer_load_dwordx4 v2, s[36:39], s78 offen offset:3072 sc1 lds
  v_max_f32_e64 v48, v48, abs(v51)
  v_cmp_le_f32 vcc, 0x60000000, v48
  v_mfma_f32_32x32x16_bf16 v[64:79], v[164:167], a[228:231], v[64:79]
  s_waitcnt lgkmcnt(2)
  ds_read_b128 a[248:251], v56 offset:47104
  v_mfma_f32_32x32x16_bf16 v[64:79], v[168:171], a[232:235], v[64:79]
  s_cbranch_vccnz L_x1retry
L_x1ok:
  s_barrier
  ds_read_b128 a[252:255], v56 offset:48128
  v_mfma_f32_32x32x16_bf16 v[64:79], v[172:175], a[236:239], v[64:79]
  s_waitcnt lgkmcnt(3)
  ds_read_b128 a[224:227], v56 offset:49152
  s_add_u32 m0, s77, 98304
  s_xor_b32 s78, s75, 163840
  v_mfma_f32_32x32x16_bf16 v[64:79], v[176:179], a[240:243], v[64:79]
  s_waitcnt lgkmcnt(3)
  ds_read_b128 a[228:231], v56 offset:50176
  buffer_load_dwordx4 v2, s[36:39], s78 offen offset:0 sc1 lds
  v_mfma_f32_32x32x16_bf16 v[64:79], v[180:183], a[244:247], v[64:79]
  s_waitcnt lgkmcnt(3)
  ds_read_b128 a[232:235], v56 offset:51200
  buffer_load_dwordx4 v2, s[36:39], s78 offen offset:1024 sc1 lds
  buffer_load_dwordx4 v2, s[36:39], s78 offen offset:2048 sc1 lds
  v_mfma_f32_32x32x16_bf16 v[64:79], v[184:187], a[248:251], v[64:79]
  s_waitcnt lgkmcnt(3)
  ds_read_b128 a[236:239], v56 offset:52224
  buffer_load_dwordx4 v2, s[36:39], s78 offen offset:3072 sc1 lds
  v_mfma_f32_32x32x16_bf16 v[64:79], v[188:191], a[252:255], v[64:79]
  s_waitcnt lgkmcnt(3)
  ds_read_b128 a[240:243], v56 offset:53248
  v_mfma_f32_32x32x16_bf16 v[64:79], v[192:195], a[224:227], v[64:79]
  s_waitcnt lgkmcnt(3)
  ds_read_b128 a[244:247], v56 offset:54272
  v_mfma_f32_32x32x16_bf16 v[64:79], v[196:199], a[228:231], v[64:79]
  s_waitcnt lgkmcnt(2)
  ds_read_b128 a[248:251], v56 offset:55296
  v_mfma_f32_32x32x16_bf16 v[64:79], v[200:203], a[232:235], v[64:79]
  s_waitcnt vmcnt(8)
  ds_read_b128 a[252:255], v56 offset:56320
  ds_read2st64_b32 v[48:49], v9 offset0:0 offset1:4
  ds_read2st64_b32 v[50:51], v9 offset0:8 offset1:12
  v_mfma_f32_32x32x16_bf16 v[64:79], v[204:207], a[236:239], v[64:79]
  s_waitcnt lgkmcnt(4)
  s_nop 0
  ds_read_b128 a[224:227], v56 offset:57344
  ds_read2st64_b32 v[52:53], v8 offset0:0 offset1:4
  ds_read2st64_b32 v[54:55], v8 offset0:8 offset1:12
  v_mfma_f32_32x32x16_bf16 v[64:79], v[208:211], a[240:243], v[64:79]
  s_add_u32 m0, s77, 114688
  ds_read_b128 a[228:231], v56 offset:58368
  s_add_u32 s78, s88, 196608
  v_mfma_f32_32x32x16_bf16 v[64:79], v[212:215], a[244:247], v[64:79]
  s_waitcnt lgkmcnt(7)
  ds_read_b128 a[232:235], v56 offset:59392
  buffer_load_dwordx4 v4, s[44:47], s78 offen offset:0  lds
  v_mfma_f32_32x32x16_bf16 v[64:79], v[216:219], a[248:251], v[64:79]
  s_waitcnt lgkmcnt(4)
  ds_read_b128 a[236:239], v56 offset:60416
  buffer_load_dwordx4 v5, s[44:47], s78 offen offset:1024  lds
  buffer_load_dwordx4 v6, s[44:47], s78 offen offset:2048  lds
  v_mfma_f32_32x32x16_bf16 v[64:79], v[220:223], a[252:255], v[64:79]
  s_waitcnt lgkmcnt(3)
  ds_read_b128 a[240:243], v56 offset:61440
  buffer_load_dwordx4 v7, s[44:47], s78 offen offset:3072  lds
  v_max3_f32 v48, abs(v48), abs(v49), abs(v50)
  v_max3_f32 v52, abs(v52), abs(v53), abs(v54)
  v_mfma_f32_32x32x16_bf16 v[64:79], v[224:227], a[224:227], v[64:79]
  s_waitcnt lgkmcnt(3)
  ds_read_b128 a[244:247], v56 offset:62464
  v_max3_f32 v48, v48, abs(v51), abs(v55)
  v_max_f32 v48, v48, v52
  v_cmp_le_f32 vcc, 0x60000000, v48
  v_mfma_f32_32x32x16_bf16 v[64:79], v[228:231], a[228:231], v[64:79]
  s_waitcnt lgkmcnt(2)
  ds_read_b128 a[248:251], v56 offset:63488
  v_mfma_f32_32x32x16_bf16 v[64:79], v[232:235], a[232:235], v[64:79]
  s_cbranch_vccnz L_x2retry
L_x2ok:
  s_barrier
  ds_read_b128 a[252:255], v56 offset:64512
  v_mfma_f32_32x32x16_bf16 v[64:79], v[236:239], a[236:239], v[64:79]
  s_waitcnt lgkmcnt(3)
  ds_read_b128 a[224:227], v57 offset:0
  v_mfma_f32_32x32x16_bf16 v[64:79], v[240:243], a[240:243], v[64:79]
  s_waitcnt lgkmcnt(3)
  ds_read_b128 a[228:231], v57 offset:1024
  v_mfma_f32_32x32x16_bf16 v[64:79], v[244:247], a[244:247], v[64:79]
  s_waitcnt lgkmcnt(3)
  ds_read_b128 a[232:235], v57 offset:2048
  buffer_store_dwordx4 v[44:47], v2, s[36:39], s100 offen offset:0 sc1
  v_mfma_f32_32x32x16_bf16 v[64:79], v[248:251], a[248:251], v[64:79]
  s_waitcnt lgkmcnt(3)
  ds_read_b128 a[236:239], v57 offset:3072
  buffer_store_dwordx4 v[44:47], v2, s[36:39], s100 offen offset:1024 sc1
  v_mfma_f32_32x32x16_bf16 v[64:79], v[252:255], a[252:255], v[64:79]
  s_waitcnt lgkmcnt(3)
  ds_read_b128 a[240:243], v57 offset:4096
  v_mfma_f32_32x32x16_bf16 v[80:95], v[128:131], a[224:227], v[112:127]
  s_waitcnt lgkmcnt(3)
  ds_read_b128 a[244:247], v57 offset:5120
  v_mfma_f32_32x32x16_bf16 v[80:95], v[132:135], a[228:231], v[80:95]
  s_waitcnt lgkmcnt(2)
  ds_read_b128 a[248:251], v57 offset:6144
  v_mfma_f32_32x32x16_bf16 v[80:95], v[136:139], a[232:235], v[80:95]
  s_add_u32 m0, s77, 16384
  ds_read_b128 a[252:255], v57 offset:7168
  s_xor_b32 s78, s75, 196608
  v_fma_f32 v40, v64, v64, s10
  v_mul_f32 v40, v40, v64
  v_exp_f32 v40, v40
  v_fma_f32 v41, v65, v65, s10
  v_mfma_f32_32x32x16_bf16 v[80:95], v[140:143], a[236:239], v[80:95]
  s_waitcnt lgkmcnt(3)
  ds_read_b128 a[224:227], v57 offset:8192
  buffer_load_dwordx4 v2, s[36:39], s78 offen offset:0 sc1 lds
  v_mul_f32 v41, v41, v65
  v_exp_f32 v41, v41
  v_fma_f32 v40, v40, s49, s49
  v_fma_f32 v41, v41, s49, s49
  v_mfma_f32_32x32x16_bf16 v[80:95], v[144:147], a[240:243], v[80:95]
  s_waitcnt lgkmcnt(3)
  ds_read_b128 a[228:231], v57 offset:9216
  buffer_load_dwordx4 v2, s[36:39], s78 offen offset:1024 sc1 lds
  buffer_load_dwordx4 v2, s[36:39], s78 offen offset:2048 sc1 lds
  v_rcp_f32 v40, v40
  v_rcp_f32 v41, v41
  v_mfma_f32_32x32x16_bf16 v[80:95], v[148:151], a[244:247], v[80:95]
  s_waitcnt lgkmcnt(3)
  ds_read_b128 a[232:235], v57 offset:10240
  buffer_load_dwordx4 v2, s[36:39], s78 offen offset:3072 sc1 lds
  v_fma_f32 v40, v40, v64, s50
  v_fma_f32 v41, v41, v65, s50
  v_cvt_pk_bf16_f32 v32, v40, v41
  v_fma_f32 v42, v66, v66, s10
  v_mul_f32 v42, v42, v66
  v_mfma_f32_32x32x16_bf16 v[80:95], v[152:155], a[248:251], v[80:95]
  s_waitcnt lgkmcnt(3)
  ds_read_b128 a[236:239], v57 offset:11264
  v_exp_f32 v42, v42
  v_fma_f32 v43, v67, v67, s10
  v_mul_f32 v43, v43, v67
  v_exp_f32 v43, v43
  v_mfma_f32_32x32x16_bf16 v[80:95], v[156:159], a[252:255], v[80:95]
  s_waitcnt lgkmcnt(3)
  ds_read_b128 a[240:243], v57 offset:12288
  v_fma_f32 v42, v42, s49, s49
  v_rcp_f32 v42, v42
  v_fma_f32 v43, v43, s49, s49
  v_rcp_f32 v43, v43
  v_mfma_f32_32x32x16_bf16 v[80:95], v[160:163], a[224:227], v[80:95]
  s_waitcnt lgkmcnt(2)
  ds_read_b128 a[244:247], v57 offset:13312
  v_fma_f32 v42, v42, v66, s50
  v_fma_f32 v43, v43, v67, s50
  v_cvt_pk_bf16_f32 v33, v42, v43
  s_xor_b32 s69, s68, 0
  v_fma_f32 v40, v68, v68, s10
  v_mul_f32 v40, v40, v68
  v_mfma_f32_32x32x16_bf16 v[80:95], v[164:167], a[228:231], v[80:95]
  s_add_u32 m0, s77, 32768
  ds_read_b128 a[248:251], v57 offset:14336
  s_xor_b32 s78, s75, 229376
  v_exp_f32 v40, v40
  v_fma_f32 v41, v69, v69, s10
  v_mul_f32 v41, v41, v69
  v_fma_f32 v40, v40, s49, s49
  v_mfma_f32_32x32x16_bf16 v[80:95], v[168:171], a[232:235], v[80:95]
  s_waitcnt lgkmcnt(3)
  ds_read_b128 a[252:255], v57 offset:15360
  buffer_load_dwordx4 v2, s[36:39], s78 offen offset:0 sc1 lds
  v_exp_f32 v41, v41
  v_rcp_f32 v40, v40
  v_fma_f32 v41, v41, s49, s49
  v_mfma_f32_32x32x16_bf16 v[80:95], v[172:175], a[236:239], v[80:95]
  s_waitcnt lgkmcnt(3)
  ds_read_b128 a[224:227], v56 offset:0
  buffer_load_dwordx4 v2, s[36:39], s78 offen offset:1024 sc1 lds
  buffer_load_dwordx4 v2, s[36:39], s78 offen offset:2048 sc1 lds
  v_rcp_f32 v41, v41
  v_fma_f32 v40, v40, v68, s50
  v_fma_f32 v41, v41, v69, s50
  v_mfma_f32_32x32x16_bf16 v[80:95], v[176:179], a[240:243], v[80:95]
  s_waitcnt lgkmcnt(3)
  ds_read_b128 a[228:231], v56 offset:1024
  buffer_load_dwordx4 v2, s[36:39], s78 offen offset:3072 sc1 lds
  v_cvt_pk_bf16_f32 v34, v40, v41
  v_fma_f32 v42, v70, v70, s10
  v_mul_f32 v42, v42, v70
  v_exp_f32 v42, v42
  v_mfma_f32_32x32x16_bf16 v[80:95], v[180:183], a[244:247], v[80:95]
  s_waitcnt lgkmcnt(3)
  ds_read_b128 a[232:235], v56 offset:2048
  v_fma_f32 v43, v71, v71, s10
  v_mul_f32 v43, v43, v71
  v_exp_f32 v43, v43
  v_fma_f32 v42, v42, s49, s49
  v_fma_f32 v43, v43, s49, s49
  v_mfma_f32_32x32x16_bf16 v[80:95], v[184:187], a[248:251], v[80:95]
  s_waitcnt lgkmcnt(3)
  ds_read_b128 a[236:239], v56 offset:3072
  v_rcp_f32 v42, v42
  v_rcp_f32 v43, v43
  v_fma_f32 v42, v42, v70, s50
  v_fma_f32 v43, v43, v71, s50
  v_mfma_f32_32x32x16_bf16 v[80:95], v[188:191], a[252:255], v[80:95]
  s_waitcnt lgkmcnt(3)
  ds_read_b128 a[240:243], v56 offset:4096
  v_cvt_pk_bf16_f32 v35, v42, v43
  v_fma_f32 v40, v72, v72, s10
  v_mul_f32 v40, v40, v72
  v_exp_f32 v40, v40
  v_fma_f32 v41, v73, v73, s10
  v_mfma_f32_32x32x16_bf16 v[80:95], v[192:195], a[224:227], v[80:95]
  s_waitcnt lgkmcnt(3)
  ds_read_b128 a[244:247], v56 offset:5120
  buffer_store_dwordx4 v[32:35], v2, s[36:39], s69 offen sc1
  v_mul_f32 v41, v41, v73
  v_mfma_f32_32x32x16_bf16 v[80:95], v[196:199], a[228:231], v[80:95]
  s_waitcnt lgkmcnt(2)
  ds_read_b128 a[248:251], v56 offset:6144
  v_exp_f32 v41, v41
  v_fma_f32 v40, v40, s49, s49
  v_rcp_f32 v40, v40
  v_fma_f32 v41, v41, s49, s49
  v_mfma_f32_32x32x16_bf16 v[80:95], v[200:203], a[232:235], v[80:95]
  s_waitcnt vmcnt(11)
  ds_read_b128 a[252:255], v56 offset:7168
  ds_read2st64_b32 v[48:49], v9 offset0:64 offset1:68
  ds_read2st64_b32 v[50:51], v9 offset0:72 offset1:76
  v_rcp_f32 v41, v41
  v_fma_f32 v40, v40, v72, s50
  v_fma_f32 v41, v41, v73, s50
  v_mfma_f32_32x32x16_bf16 v[80:95], v[204:207], a[236:239], v[80:95]
  s_waitcnt lgkmcnt(5)
  ds_read_b128 a[224:227], v56 offset:8192
  ds_read2st64_b32 v[52:53], v9 offset0:128 offset1:132
  ds_read2st64_b32 v[54:55], v9 offset0:136 offset1:140
  v_cvt_pk_bf16_f32 v36, v40, v41
  v_fma_f32 v42, v74, v74, s10
  v_mul_f32 v42, v42, v74
  v_fma_f32 v43, v75, v75, s10
  v_mfma_f32_32x32x16_bf16 v[80:95], v[208:211], a[240:243], v[80:95]
  s_waitcnt lgkmcnt(6)
  ds_read_b128 a[228:231], v56 offset:9216
  v_exp_f32 v42, v42
  v_mul_f32 v43, v43, v75
  v_exp_f32 v43, v43
  v_fma_f32 v42, v42, s49, s49
  v_mfma_f32_32x32x16_bf16 v[80:95], v[212:215], a[244:247], v[80:95]
  s_add_u32 m0, s77, 131072
  ds_read_b128 a[232:235], v56 offset:10240
  s_add_u32 s78, s88, 262144
  v_rcp_f32 v42, v42
  v_fma_f32 v43, v43, s49, s49
  v_rcp_f32 v43, v43
  v_mfma_f32_32x32x16_bf16 v[80:95], v[216:219], a[248:251], v[80:95]
  s_waitcnt lgkmcnt(4)
  ds_read_b128 a[236:239], v56 offset:11264
  buffer_load_dwordx4 v4, s[44:47], s78 offen offset:0  lds
  v_fma_f32 v42, v42, v74, s50
  v_fma_f32 v43, v43, v75, s50
  v_cvt_pk_bf16_f32 v37, v42, v43
  s_xor_b32 s69, s68, 32768
  v_fma_f32 v40, v76, v76, s10
  v_mfma_f32_32x32x16_bf16 v[80:95], v[220:223], a[252:255], v[80:95]
  s_waitcnt lgkmcnt(3)
  ds_read_b128 a[240:243], v56 offset:12288
  buffer_load_dwordx4 v5, s[44:47], s78 offen offset:1024  lds
  buffer_load_dwordx4 v6, s[44:47], s78 offen offset:2048  lds
  v_max3_f32 v48, abs(v48), abs(v49), abs(v50)
  v_max3_f32 v52, abs(v52), abs(v53), abs(v54)
  v_mul_f32 v40, v40, v76
  v_fma_f32 v41, v77, v77, s10
  v_mfma_f32_32x32x16_bf16 v[80:95], v[224:227], a[224:227], v[80:95]
  s_waitcnt lgkmcnt(3)
  ds_read_b128 a[244:247], v56 offset:13312
  buffer_load_dwordx4 v7, s[44:47], s78 offen offset:3072  lds
  v_max3_f32 v48, v48, abs(v51), abs(v55)
  v_max_f32 v48, v48, v52
  v_cmp_le_f32 vcc, 0x60000000, v48
  v_exp_f32 v40, v40
  v_mfma_f32_32x32x16_bf16 v[80:95], v[228:231], a[228:231], v[80:95]
  s_waitcnt lgkmcnt(2)
  ds_read_b128 a[248:251], v56 offset:14336
  v_mul_f32 v41, v41, v77
  v_exp_f32 v41, v41
  v_fma_f32 v40, v40, s49, s49
  v_rcp_f32 v40, v40
  v_mfma_f32_32x32x16_bf16 v[80:95], v[232:235], a[232:235], v[80:95]
  s_cbranch_vccnz L_x4retry
L_x4ok:
  s_barrier
  ds_read_b128 a[252:255], v56 offset:15360
  s_add_u32 m0, s77, 147456
  s_add_u32 s78, s88, 327680
  v_fma_f32 v41, v41, s49, s49
  v_rcp_f32 v41, v41
  v_mfma_f32_32x32x16_bf16 v[80:95], v[236:239], a[236:239], v[80:95]
  s_waitcnt lgkmcnt(3)
  s_nop 0
  ds_read_b128 a[224:227], v57 offset:16384
  buffer_load_dwordx4 v4, s[44:47], s78 offen offset:0  lds
  ds_read_b64_tr_b16 a[48:49], v29 offset:49152
  v_fma_f32 v40, v40, v76, s50
  v_fma_f32 v41, v41, v77, s50
  v_cvt_pk_bf16_f32 v38, v40, v41
  v_fma_f32 v42, v78, v78, s10
  v_mfma_f32_32x32x16_bf16 v[80:95], v[240:243], a[240:243], v[80:95]
  s_waitcnt lgkmcnt(4)
  ds_read_b128 a[228:231], v57 offset:17408
  buffer_load_dwordx4 v5, s[44:47], s78 offen offset:1024  lds
  buffer_load_dwordx4 v6, s[44:47], s78 offen offset:2048  lds
  ds_read_b64_tr_b16 a[50:51], v29 offset:51200
  ds_read_b64_tr_b16 a[52:53], v29 offset:53248
  v_mul_f32 v42, v42, v78
  v_fma_f32 v43, v79, v79, s10
  v_mfma_f32_32x32x16_bf16 v[80:95], v[244:247], a[244:247], v[80:95]
  s_waitcnt lgkmcnt(6)
  ds_read_b128 a[232:235], v57 offset:18432
  buffer_load_dwordx4 v7, s[44:47], s78 offen offset:3072  lds
  ds_read_b64_tr_b16 a[54:55], v29 offset:55296
  v_exp_f32 v42, v42
  v_mul_f32 v43, v43, v79
  v_fma_f32 v42, v42, s49, s49
  v_mfma_f32_32x32x16_bf16 v[80:95], v[248:251], a[248:251], v[80:95]
  s_waitcnt lgkmcnt(7)
  ds_read_b128 a[236:239], v57 offset:19456
  ds_read_b64_tr_b16 a[56:57], v29 offset:57344
  v_exp_f32 v43, v43
  v_rcp_f32 v42, v42
  v_fma_f32 v43, v43, s49, s49
  v_mfma_f32_32x32x16_bf16 v[80:95], v[252:255], a[252:255], v[80:95]
  s_waitcnt lgkmcnt(8)
  ds_read_b128 a[240:243], v57 offset:20480
  ds_read_b64_tr_b16 a[58:59], v29 offset:59392
  ds_read_b64_tr_b16 a[60:61], v29 offset:61440
  v_rcp_f32 v43, v43
  v_fma_f32 v42, v42, v78, s50
  v_fma_f32 v43, v43, v79, s50
  v_cvt_pk_bf16_f32 v39, v42, v43
  v_mfma_f32_32x32x16_bf16 v[64:79], v[128:131], a[224:227], v[112:127]
  s_waitcnt lgkmcnt(9)
  ds_read_b128 a[244:247], v57 offset:21504
  ds_read_b64_tr_b16 a[62:63], v29 offset:63488
  buffer_store_dwordx4 v[36:39], v2, s[36:39], s69 offen sc1
  v_mfma_f32_32x32x16_bf16 v[64:79], v[132:135], a[228:231], v[64:79]
  s_waitcnt lgkmcnt(8)
  ds_read_b128 a[248:251], v57 offset:22528
  v_fma_f32 v40, v80, v80, s10
  v_mul_f32 v40, v40, v80
  v_exp_f32 v40, v40
  v_fma_f32 v41, v81, v81, s10
  v_mfma_f32_32x32x16_bf16 v[64:79], v[136:139], a[232:235], v[64:79]
  s_waitcnt lgkmcnt(7)
  ds_read_b128 a[252:255], v57 offset:23552
  v_mul_f32 v41, v41, v81
  v_exp_f32 v41, v41
  v_fma_f32 v40, v40, s49, s49
  v_fma_f32 v41, v41, s49, s49
  v_mfma_f32_32x32x16_bf16 v[64:79], v[140:143], a[236:239], v[64:79]
  s_waitcnt lgkmcnt(6)
  ds_read_b128 a[224:227], v57 offset:24576
  v_rcp_f32 v40, v40
  v_rcp_f32 v41, v41
  v_fma_f32 v40, v40, v80, s50
  v_fma_f32 v41, v41, v81, s50
  v_mfma_f32_32x32x16_bf16 v[64:79], v[144:147], a[240:243], v[64:79]
  s_waitcnt lgkmcnt(4)
  ds_read_b128 a[228:231], v57 offset:25600
  v_cvt_pk_bf16_f32 v32, v40, v41
  v_fma_f32 v42, v82, v82, s10
  v_mul_f32 v42, v42, v82
  v_exp_f32 v42, v42
  v_mfma_f32_32x32x16_bf16 v[64:79], v[148:151], a[244:247], v[64:79]
  s_waitcnt lgkmcnt(2)
  ds_read_b128 a[232:235], v57 offset:26624
  v_fma_f32 v43, v83, v83, s10
  v_mul_f32 v43, v43, v83
  v_exp_f32 v43, v43
  v_fma_f32 v42, v42, s49, s49
  v_fma_f32 v43, v43, s49, s49
  v_mfma_f32_32x32x16_bf16 v[64:79], v[152:155], a[248:251], v[64:79]
  s_add_u32 m0, s77, 49152
  ds_read_b128 a[236:239], v57 offset:27648
  s_add_u32 s78, s88, 393216
  v_rcp_f32 v42, v42
  v_rcp_f32 v43, v43
  v_mfma_f32_32x32x16_bf16 v[64:79], v[156:159], a[252:255], v[64:79]
  s_waitcnt lgkmcnt(3)
  s_nop 0
  ds_read_b128 a[240:243], v57 offset:28672
  buffer_load_dwordx4 v4, s[44:47], s78 offen offset:0  lds
  v_fma_f32 v42, v42, v82, s50
  v_fma_f32 v43, v43, v83, s50
  v_cvt_pk_bf16_f32 v33, v42, v43
  s_xor_b32 s69, s68, 262144
  v_fma_f32 v40, v84, v84, s10
  v_mfma_f32_32x32x16_bf16 v[64:79], v[160:163], a[224:227], v[64:79]
  s_waitcnt lgkmcnt(3)
  ds_read_b128 a[244:247], v57 offset:29696
  buffer_load_dwordx4 v5, s[44:47], s78 offen offset:1024  lds
  buffer_load_dwordx4 v6, s[44:47], s78 offen offset:2048  lds
  v_mul_f32 v40, v40, v84
  v_exp_f32 v40, v40
  v_mfma_f32_32x32x16_bf16 v[64:79], v[164:167], a[228:231], v[64:79]
  s_waitcnt lgkmcnt(3)
  ds_read_b128 a[248:251], v57 offset:30720
  buffer_load_dwordx4 v7, s[44:47], s78 offen offset:3072  lds
  v_fma_f32 v41, v85, v85, s10
  v_mul_f32 v41, v41, v85
  v_exp_f32 v41, v41
  v_fma_f32 v40, v40, s49, s49
  v_mfma_f32_32x32x16_bf16 v[64:79], v[168:171], a[232:235], v[64:79]
  s_waitcnt lgkmcnt(2)
  ds_read_b128 a[252:255], v57 offset:31744
  v_rcp_f32 v40, v40
  v_fma_f32 v41, v41, s49, s49
  v_rcp_f32 v41, v41
  v_mfma_f32_32x32x16_bf16 v[64:79], v[172:175], a[236:239], v[64:79]
  s_waitcnt vmcnt(9)
  ds_read_b128 a[224:227], v57 offset:32768
  ds_read2st64_b32 v[48:49], v8 offset0:64 offset1:68
  ds_read2st64_b32 v[50:51], v8 offset0:72 offset1:76
  v_fma_f32 v40, v40, v84, s50
  v_fma_f32 v41, v41, v85, s50
  v_cvt_pk_bf16_f32 v34, v40, v41
  v_fma_f32 v42, v86, v86, s10
  v_mfma_f32_32x32x16_bf16 v[64:79], v[176:179], a[240:243], v[64:79]
  s_waitcnt lgkmcnt(5)
  ds_read_b128 a[228:231], v57 offset:33792
  ds_read2st64_b32 v[52:53], v8 offset0:128 offset1:132
  ds_read2st64_b32 v[54:55], v8 offset0:136 offset1:140
  v_mul_f32 v42, v42, v86
  v_exp_f32 v42, v42
  v_mfma_f32_32x32x16_bf16 v[64:79], v[180:183], a[244:247], v[64:79]
  s_waitcnt lgkmcnt(7)
  ds_read_b128 a[232:235], v57 offset:34816
  v_fma_f32 v43, v87, v87, s10
  v_mul_f32 v43, v43, v87
  v_exp_f32 v43, v43
  v_fma_f32 v42, v42, s49, s49
  v_fma_f32 v43, v43, s49, s49
  v_mfma_f32_32x32x16_bf16 v[64:79], v[184:187], a[248:251], v[64:79]
  s_waitcnt lgkmcnt(7)
  ds_read_b128 a[236:239], v57 offset:35840
  v_rcp_f32 v42, v42
  v_rcp_f32 v43, v43
  v_fma_f32 v42, v42, v86, s50
  v_mfma_f32_32x32x16_bf16 v[64:79], v[188:191], a[252:255], v[64:79]
  s_waitcnt lgkmcnt(4)
  ds_read_b128 a[240:243], v57 offset:36864
  v_fma_f32 v43, v43, v87, s50
  v_cvt_pk_bf16_f32 v35, v42, v43
  v_fma_f32 v40, v88, v88, s10
  v_mul_f32 v40, v40, v88
  v_exp_f32 v40, v40
  v_mfma_f32_32x32x16_bf16 v[64:79], v[192:195], a[224:227], v[64:79]
  s_waitcnt lgkmcnt(3)
  ds_read_b128 a[244:247], v57 offset:37888
  buffer_store_dwordx4 v[32:35], v2, s[36:39], s69 offen sc1
  v_max3_f32 v48, abs(v48), abs(v49), abs(v50)
  v_max3_f32 v52, abs(v52), abs(v53), abs(v54)
  v_mfma_f32_32x32x16_bf16 v[64:79], v[196:199], a[228:231], v[64:79]
  s_waitcnt lgkmcnt(3)
  ds_read_b128 a[248:251], v57 offset:38912
  v_max3_f32 v48, v48, abs(v51), abs(v55)
  v_max_f32 v48, v48, v52
  v_cmp_le_f32 vcc, 0x60000000, v48
  v_fma_f32 v41, v89, v89, s10
  v_mul_f32 v41, v41, v89
  v_fma_f32 v40, v40, s49, s49
  v_mfma_f32_32x32x16_bf16 v[64:79], v[200:203], a[232:235], v[64:79]
  s_waitcnt lgkmcnt(2)
  ds_read_b128 a[252:255], v57 offset:39936
  v_exp_f32 v41, v41
  v_rcp_f32 v40, v40
  v_fma_f32 v41, v41, s49, s49
  v_mfma_f32_32x32x16_bf16 v[64:79], v[204:207], a[236:239], v[64:79]
  s_cbranch_vccnz L_x6retry
L_x6ok:
  s_barrier
  ds_read_b128 a[224:227], v57 offset:40960
  v_rcp_f32 v41, v41
  v_fma_f32 v40, v40, v88, s50
  v_fma_f32 v41, v41, v89, s50
  v_cvt_pk_bf16_f32 v36, v40, v41
  v_mfma_f32_32x32x16_bf16 v[64:79], v[208:211], a[240:243], v[64:79]
  s_waitcnt lgkmcnt(2)
  ds_read_b128 a[228:231], v57 offset:41984
  s_waitcnt vmcnt(14)
  s_add_u32 m0, s71, 0
  ds_read_b64_tr_b16 a[64:65], v15 offset:0
  v_fma_f32 v42, v90, v90, s10
  v_mul_f32 v42, v42, v90
  v_mfma_f32_32x32x16_bf16 v[64:79], v[212:215], a[244:247], v[64:79]
  s_xor_b32 s78, s70, 0
  ds_read_b128 a[232:235], v57 offset:43008
  buffer_load_dwordx4 v2, s[36:39], s78 offen offset:0 sc1 lds
  ds_read_b64_tr_b16 a[66:67], v15 offset:2048
  ds_read_b64_tr_b16 a[68:69], v15 offset:4096
  v_exp_f32 v42, v42
  v_fma_f32 v43, v91, v91, s10
  v_mfma_f32_32x32x16_bf16 v[64:79], v[216:219], a[248:251], v[64:79]
  s_waitcnt lgkmcnt(6)
  ds_read_b128 a[236:239], v57 offset:44032
  buffer_load_dwordx4 v2, s[36:39], s78 offen offset:1024 sc1 lds
  ds_read_b64_tr_b16 a[70:71], v15 offset:6144
  v_mul_f32 v43, v43, v91
  v_exp_f32 v43, v43
  v_mfma_f32_32x32x16_bf16 v[64:79], v[220:223], a[252:255], v[64:79]
  s_waitcnt lgkmcnt(7)
  ds_read_b128 a[240:243], v57 offset:45056
  buffer_load_dwordx4 v2, s[36:39], s78 offen offset:2048 sc1 lds
  buffer_load_dwordx4 v2, s[36:39], s78 offen offset:3072 sc1 lds
  ds_read_b64_tr_b16 a[72:73], v15 offset:8192
  v_fma_f32 v42, v42, s49, s49
  v_rcp_f32 v42, v42
  v_mfma_f32_32x32x16_bf16 v[64:79], v[224:227], a[224:227], v[64:79]
  s_waitcnt lgkmcnt(8)
  ds_read_b128 a[244:247], v57 offset:46080
  ds_read_b64_tr_b16 a[74:75], v15 offset:10240
  ds_read_b64_tr_b16 a[76:77], v15 offset:12288
  v_fma_f32 v43, v43, s49, s49
  v_rcp_f32 v43, v43
  v_mfma_f32_32x32x16_bf16 v[64:79], v[228:231], a[228:231], v[64:79]
  s_waitcnt lgkmcnt(9)
  ds_read_b128 a[248:251], v57 offset:47104
  ds_read_b64_tr_b16 a[78:79], v15 offset:14336
  v_fma_f32 v42, v42, v90, s50
  v_fma_f32 v43, v43, v91, s50
  v_cvt_pk_bf16_f32 v37, v42, v43
  s_xor_b32 s69, s68, 294912
  v_fma_f32 v40, v92, v92, s10
  v_mfma_f32_32x32x16_bf16 v[64:79], v[232:235], a[232:235], v[64:79]
  s_waitcnt lgkmcnt(8)
  ds_read_b128 a[252:255], v57 offset:48128
  v_mul_f32 v40, v40, v92
  v_exp_f32 v40, v40
  v_fma_f32 v41, v93, v93, s10
  v_mul_f32 v41, v41, v93
  v_mfma_f32_32x32x16_bf16 v[64:79], v[236:239], a[236:239], v[64:79]
  s_waitcnt lgkmcnt(7)
  ds_read_b128 a[224:227], v56 offset:16384
  v_exp_f32 v41, v41
  v_fma_f32 v40, v40, s49, s49
  v_rcp_f32 v40, v40
  v_fma_f32 v41, v41, s49, s49
  v_mfma_f32_32x32x16_bf16 v[64:79], v[240:243], a[240:243], v[64:79]
  s_waitcnt lgkmcnt(6)
  ds_read_b128 a[228:231], v56 offset:17408
  v_rcp_f32 v41, v41
  v_fma_f32 v40, v40, v92, s50
  v_fma_f32 v41, v41, v93, s50
  v_cvt_pk_bf16_f32 v38, v40, v41
  v_mfma_f32_32x32x16_bf16 v[64:79], v[244:247], a[244:247], v[64:79]
  s_waitcnt lgkmcnt(4)
  ds_read_b128 a[232:235], v56 offset:18432
  v_fma_f32 v42, v94, v94, s10
  v_mul_f32 v42, v42, v94
  v_exp_f32 v42, v42
  v_fma_f32 v43, v95, v95, s10
  v_mul_f32 v43, v43, v95
  v_mfma_f32_32x32x16_bf16 v[64:79], v[248:251], a[248:251], v[64:79]
  s_waitcnt lgkmcnt(3)
  ds_read_b128 a[236:239], v56 offset:19456
  v_exp_f32 v43, v43
  v_fma_f32 v42, v42, s49, s49
  v_rcp_f32 v42, v42
  v_mfma_f32_32x32x16_bf16 v[64:79], v[252:255], a[252:255], v[64:79]
  s_waitcnt lgkmcnt(3)
  ds_read_b128 a[240:243], v56 offset:20480
  v_fma_f32 v43, v43, s49, s49
  v_rcp_f32 v43, v43
  v_fma_f32 v42, v42, v94, s50
  v_fma_f32 v43, v43, v95, s50
  v_cvt_pk_bf16_f32 v39, v42, v43
  v_mfma_f32_32x32x16_bf16 v[80:95], v[128:131], a[224:227], v[112:127]
  s_waitcnt lgkmcnt(3)
  ds_read_b128 a[244:247], v56 offset:21504
  buffer_store_dwordx4 v[36:39], v2, s[36:39], s69 offen sc1
  v_mfma_f32_32x32x16_bf16 v[80:95], v[132:135], a[228:231], v[80:95]
  s_waitcnt lgkmcnt(3)
  ds_read_b128 a[248:251], v56 offset:22528
  v_fma_f32 v40, v64, v64, s10
  v_mul_f32 v40, v40, v64
  v_exp_f32 v40, v40
  v_fma_f32 v41, v65, v65, s10
  v_mfma_f32_32x32x16_bf16 v[80:95], v[136:139], a[232:235], v[80:95]
  s_waitcnt lgkmcnt(3)
  ds_read_b128 a[252:255], v56 offset:23552
  v_mul_f32 v41, v41, v65
  v_exp_f32 v41, v41
  v_fma_f32 v40, v40, s49, s49
  v_rcp_f32 v40, v40
L_hop61:
  s_cbranch_execz L_wb2
  v_mfma_f32_32x32x16_bf16 v[80:95], v[140:143], a[236:239], v[80:95]
  s_waitcnt lgkmcnt(2)
  ds_read_b128 a[224:227], v56 offset:24576
  v_fma_f32 v41, v41, s49, s49
  v_rcp_f32 v41, v41
  v_fma_f32 v40, v40, v64, s50
  v_fma_f32 v41, v41, v65, s50
  v_cvt_pk_bf16_f32 v32, v40, v41
  v_mfma_f32_32x32x16_bf16 v[80:95], v[144:147], a[240:243], v[80:95]
  s_waitcnt vmcnt(10)
  ds_read_b128 a[228:231], v56 offset:25600
  s_add_u32 m0, s71, 65536
  v_fma_f32 v42, v66, v66, s10
  v_mul_f32 v42, v42, v66
  v_exp_f32 v42, v42
  v_mfma_f32_32x32x16_bf16 v[80:95], v[148:151], a[244:247], v[80:95]
  s_waitcnt lgkmcnt(3)
  ds_read_b128 a[232:235], v56 offset:26624
  s_xor_b32 s78, s70, 32768
  buffer_load_dwordx4 v2, s[36:39], s78 offen offset:0 sc1 lds
  v_fma_f32 v43, v67, v67, s10
  v_mul_f32 v43, v43, v67
  v_exp_f32 v43, v43
  v_mfma_f32_32x32x16_bf16 v[80:95], v[152:155], a[248:251], v[80:95]
  s_waitcnt lgkmcnt(3)
  ds_read_b128 a[236:239], v56 offset:27648
  buffer_load_dwordx4 v2, s[36:39], s78 offen offset:1024 sc1 lds
  v_fma_f32 v42, v42, s49, s49
  v_rcp_f32 v42, v42
  v_fma_f32 v43, v43, s49, s49
  v_fma_f32 v42, v42, v66, s50
  v_mfma_f32_32x32x16_bf16 v[80:95], v[156:159], a[252:255], v[80:95]
  s_waitcnt lgkmcnt(3)
  ds_read_b128 a[240:243], v56 offset:28672
  buffer_load_dwordx4 v2, s[36:39], s78 offen offset:2048 sc1 lds
  buffer_load_dwordx4 v2, s[36:39], s78 offen offset:3072 sc1 lds
  v_rcp_f32 v43, v43
  v_mfma_f32_32x32x16_bf16 v[80:95], v[160:163], a[224:227], v[80:95]
  s_waitcnt lgkmcnt(3)
  ds_read_b128 a[244:247], v56 offset:29696
  v_fma_f32 v43, v43, v67, s50
  v_cvt_pk_bf16_f32 v33, v42, v43
  s_xor_b32 s69, s68, 524288
  v_fma_f32 v40, v68, v68, s10
  v_mul_f32 v40, v40, v68
  v_fma_f32 v41, v69, v69, s10
  v_mfma_f32_32x32x16_bf16 v[80:95], v[164:167], a[228:231], v[80:95]
  s_waitcnt lgkmcnt(3)
  ds_read_b128 a[248:251], v56 offset:30720
  v_exp_f32 v40, v40
  v_mul_f32 v41, v41, v69
  v_exp_f32 v41, v41
  v_fma_f32 v40, v40, s49, s49
  v_mfma_f32_32x32x16_bf16 v[80:95], v[168:171], a[232:235], v[80:95]
  s_waitcnt lgkmcnt(3)
  ds_read_b128 a[252:255], v56 offset:31744
  v_rcp_f32 v40, v40
  v_fma_f32 v41, v41, s49, s49
  v_rcp_f32 v41, v41
  v_fma_f32 v40, v40, v68, s50
  v_mfma_f32_32x32x16_bf16 v[80:95], v[172:175], a[236:239], v[80:95]
  s_waitcnt lgkmcnt(3)
  ds_read_b128 a[224:227], v56 offset:32768
  v_fma_f32 v41, v41, v69, s50
  v_cvt_pk_bf16_f32 v34, v40, v41
  v_fma_f32 v42, v70, v70, s10
  v_mul_f32 v42, v42, v70
  v_fma_f32 v43, v71, v71, s10
  v_mfma_f32_32x32x16_bf16 v[80:95], v[176:179], a[240:243], v[80:95]
  s_waitcnt lgkmcnt(3)
  ds_read_b128 a[228:231], v56 offset:33792
  v_exp_f32 v42, v42
  v_mul_f32 v43, v43, v71
  v_exp_f32 v43, v43
  v_fma_f32 v42, v42, s49, s49
  v_mfma_f32_32x32x16_bf16 v[80:95], v[180:183], a[244:247], v[80:95]
  s_waitcnt lgkmcnt(3)
  ds_read_b128 a[232:235], v56 offset:34816
  v_rcp_f32 v42, v42
  v_fma_f32 v43, v43, s49, s49
  v_rcp_f32 v43, v43
  v_fma_f32 v42, v42, v70, s50
  v_mfma_f32_32x32x16_bf16 v[80:95], v[184:187], a[248:251], v[80:95]
  s_waitcnt lgkmcnt(3)
  ds_read_b128 a[236:239], v56 offset:35840
  v_fma_f32 v43, v43, v71, s50
  v_cvt_pk_bf16_f32 v35, v42, v43
  v_fma_f32 v40, v72, v72, s10
  v_mul_f32 v40, v40, v72
  v_fma_f32 v41, v73, v73, s10
  v_mfma_f32_32x32x16_bf16 v[80:95], v[188:191], a[252:255], v[80:95]
  s_waitcnt lgkmcnt(3)
  ds_read_b128 a[240:243], v56 offset:36864
  buffer_store_dwordx4 v[32:35], v2, s[36:39], s69 offen sc1
  v_mul_f32 v41, v41, v73
  v_mfma_f32_32x32x16_bf16 v[80:95], v[192:195], a[224:227], v[80:95]
  s_waitcnt lgkmcnt(3)
  ds_read_b128 a[244:247], v56 offset:37888
  v_exp_f32 v40, v40
  v_exp_f32 v41, v41
  v_fma_f32 v40, v40, s49, s49
  v_fma_f32 v41, v41, s49, s49
  v_mfma_f32_32x32x16_bf16 v[80:95], v[196:199], a[228:231], v[80:95]
  s_waitcnt lgkmcnt(2)
  ds_read_b128 a[248:251], v56 offset:38912
  v_rcp_f32 v40, v40
  v_rcp_f32 v41, v41
  v_fma_f32 v40, v40, v72, s50
  v_fma_f32 v41, v41, v73, s50
  v_mfma_f32_32x32x16_bf16 v[80:95], v[200:203], a[232:235], v[80:95]
  s_waitcnt vmcnt(6)
  ds_read_b128 a[252:255], v56 offset:39936
  ds_read2st64_b64 v[44:47], v12 offset0:0 offset1:2
  s_waitcnt vmcnt(10)
  s_add_u32 m0, s71, 81920
  v_cvt_pk_bf16_f32 v36, v40, v41
  v_fma_f32 v42, v74, v74, s10
  v_mfma_f32_32x32x16_bf16 v[80:95], v[204:207], a[236:239], v[80:95]
  s_waitcnt lgkmcnt(4)
  ds_read_b128 a[224:227], v56 offset:40960
  ds_read2st64_b64 v[48:51], v12 offset0:4 offset1:6
  s_xor_b32 s78, s70, 262144
  buffer_load_dwordx4 v2, s[36:39], s78 offen offset:0 sc1 lds
  v_mul_f32 v42, v42, v74
  v_exp_f32 v42, v42
  v_mfma_f32_32x32x16_bf16 v[80:95], v[208:211], a[240:243], v[80:95]
  s_waitcnt lgkmcnt(5)
  ds_read_b128 a[228:231], v56 offset:41984
  buffer_load_dwordx4 v2, s[36:39], s78 offen offset:1024 sc1 lds
  v_fma_f32 v43, v75, v75, s10
  v_mul_f32 v43, v43, v75
  v_exp_f32 v43, v43
  v_fma_f32 v42, v42, s49, s49
  v_mfma_f32_32x32x16_bf16 v[80:95], v[212:215], a[244:247], v[80:95]
  s_waitcnt lgkmcnt(5)
  ds_read_b128 a[232:235], v56 offset:43008
  buffer_load_dwordx4 v2, s[36:39], s78 offen offset:2048 sc1 lds
  buffer_load_dwordx4 v2, s[36:39], s78 offen offset:3072 sc1 lds
  v_rcp_f32 v42, v42
  v_fma_f32 v43, v43, s49, s49
  v_mfma_f32_32x32x16_bf16 v[80:95], v[216:219], a[248:251], v[80:95]
  s_waitcnt lgkmcnt(3)
  ds_read_b128 a[236:239], v56 offset:44032
  v_rcp_f32 v43, v43
  v_fma_f32 v42, v42, v74, s50
  v_fma_f32 v43, v43, v75, s50
  v_cvt_pk_bf16_f32 v37, v42, v43
  s_xor_b32 s69, s68, 557056
  v_mfma_f32_32x32x16_bf16 v[80:95], v[220:223], a[252:255], v[80:95]
  s_waitcnt lgkmcnt(3)
  ds_read_b128 a[240:243], v56 offset:45056
  global_load_dwordx4 v[20:23], v16, s[8:9] offset:0
  v_bitop3_b32 v44, v44, v45, s48 bitop3:0x7e
  v_bitop3_b32 v46, v46, v47, s48 bitop3:0x7e
  v_bitop3_b32 v48, v48, v49, s48 bitop3:0x7e
  v_fma_f32 v40, v76, v76, s10
  v_mul_f32 v40, v40, v76
  v_mfma_f32_32x32x16_bf16 v[80:95], v[224:227], a[224:227], v[80:95]
  s_waitcnt lgkmcnt(3)
  ds_read_b128 a[244:247], v56 offset:46080
  v_bitop3_b32 v50, v50, v51, s48 bitop3:0x7e
  v_or3_b32 v44, v44, v46, v48
  v_bitop3_b32 v44, v44, v50, v27 bitop3:0xa8
  v_cmp_ne_u32 vcc, 0, v44
  v_exp_f32 v40, v40
  v_mfma_f32_32x32x16_bf16 v[80:95], v[228:231], a[228:231], v[80:95]
  s_waitcnt lgkmcnt(2)
  ds_read_b128 a[248:251], v56 offset:47104
  v_fma_f32 v41, v77, v77, s10
  v_mul_f32 v41, v41, v77
  v_exp_f32 v41, v41
  v_fma_f32 v40, v40, s49, s49
  v_mfma_f32_32x32x16_bf16 v[80:95], v[232:235], a[232:235], v[80:95]
  s_cbranch_vccnz L_x8retry
L_x8ok:
  s_barrier
  ds_read_b128 a[252:255], v56 offset:48128
  global_load_dwordx4 v[60:63], v16, s[8:9] offset:16
  v_rcp_f32 v40, v40
  v_fma_f32 v41, v41, s49, s49
  v_fma_f32 v40, v40, v76, s50
  v_mfma_f32_32x32x16_bf16 v[80:95], v[236:239], a[236:239], v[80:95]
  s_waitcnt lgkmcnt(3)
  ds_read_b128 a[224:227], v2 offset:0
  ds_read_b64_tr_b16 a[80:81], v15 offset:16384
  v_rcp_f32 v41, v41
  v_fma_f32 v42, v78, v78, s10
  v_fma_f32 v41, v41, v77, s50
  v_cvt_pk_bf16_f32 v38, v40, v41
  v_mfma_f32_32x32x16_bf16 v[80:95], v[240:243], a[240:243], v[80:95]
  s_waitcnt lgkmcnt(4)
  ds_read_b128 a[228:231], v2 offset:1024
  ds_read_b64_tr_b16 a[82:83], v15 offset:18432
  ds_read_b64_tr_b16 a[84:85], v15 offset:20480
  v_mul_f32 v42, v42, v78
  v_exp_f32 v42, v42
  v_mfma_f32_32x32x16_bf16 v[80:95], v[244:247], a[244:247], v[80:95]
  s_waitcnt lgkmcnt(6)
  ds_read_b128 a[232:235], v2 offset:2048
  ds_read_b64_tr_b16 a[86:87], v15 offset:22528
  v_fma_f32 v43, v79, v79, s10
  v_mul_f32 v43, v43, v79
  v_exp_f32 v43, v43
  v_fma_f32 v42, v42, s49, s49
  v_mfma_f32_32x32x16_bf16 v[80:95], v[248:251], a[248:251], v[80:95]
  s_waitcnt lgkmcnt(7)
  ds_read_b128 a[236:239], v2 offset:3072
  ds_read_b64_tr_b16 a[88:89], v15 offset:24576
  v_rcp_f32 v42, v42
  v_fma_f32 v43, v43, s49, s49
  v_rcp_f32 v43, v43
  v_mfma_f32_32x32x16_bf16 v[80:95], v[252:255], a[252:255], v[80:95]
  s_waitcnt lgkmcnt(6)
  ds_read_b128 a[240:243], v2 offset:4096
  ds_read_b64_tr_b16 a[90:91], v15 offset:26624
  ds_read_b64_tr_b16 a[92:93], v15 offset:28672
  v_fma_f32 v42, v42, v78, s50
  v_fma_f32 v43, v43, v79, s50
  v_cvt_pk_bf16_f32 v39, v42, v43
  v_mfma_f32_32x32x16_bf16 v[96:111], a[0:3], a[224:227], 0
  s_waitcnt vmcnt(7)
  ds_read_b128 a[244:247], v2 offset:5120
  ds_read2st64_b64 v[44:47], v13 offset0:0 offset1:2
  s_waitcnt vmcnt(11)
  s_add_u32 m0, s71, 16384
  ds_read_b64_tr_b16 a[94:95], v15 offset:30720
  buffer_store_dwordx4 v[36:39], v2, s[36:39], s69 offen sc1
  v_mfma_f32_32x32x16_bf16 v[96:111], a[8:11], a[228:231], v[96:111]
  s_waitcnt lgkmcnt(9)
  ds_read_b128 a[248:251], v2 offset:6144
  ds_read2st64_b64 v[48:51], v13 offset0:4 offset1:6
  s_xor_b32 s78, s70, 294912
  buffer_load_dwordx4 v2, s[36:39], s78 offen offset:0 sc1 lds
  ds_read_b64_tr_b16 a[96:97], v28 offset:49152
  v_fma_f32 v40, v80, v80, s10
  v_mul_f32 v40, v40, v80
  v_mfma_f32_32x32x16_bf16 v[96:111], a[16:19], a[232:235], v[96:111]
  s_waitcnt lgkmcnt(10)
  ds_read_b128 a[252:255], v2 offset:7168
  buffer_load_dwordx4 v2, s[36:39], s78 offen offset:1024 sc1 lds
  ds_read_b64_tr_b16 a[98:99], v28 offset:51200
  ds_read_b64_tr_b16 a[100:101], v28 offset:53248
  v_exp_f32 v40, v40
  v_fma_f32 v41, v81, v81, s10
  v_mfma_f32_32x32x16_bf16 v[96:111], a[24:27], a[236:239], v[96:111]
  s_waitcnt lgkmcnt(11)
  ds_read_b128 a[224:227], v2 offset:8192
  buffer_load_dwordx4 v2, s[36:39], s78 offen offset:2048 sc1 lds
  buffer_load_dwordx4 v2, s[36:39], s78 offen offset:3072 sc1 lds
  ds_read_b64_tr_b16 a[102:103], v28 offset:55296
  v_mul_f32 v41, v41, v81
  v_exp_f32 v41, v41
  v_mfma_f32_32x32x16_bf16 v[96:111], a[32:35], a[240:243], v[96:111]
  s_waitcnt lgkmcnt(7)
  ds_read_b128 a[228:231], v2 offset:9216
  ds_read_b64_tr_b16 a[104:105], v28 offset:57344
  v_fma_f32 v40, v40, s49, s49
  v_rcp_f32 v40, v40
  v_fma_f32 v41, v41, s49, s49
  v_rcp_f32 v41, v41
  v_mfma_f32_32x32x16_bf16 v[96:111], a[40:43], a[244:247], v[96:111]
  s_waitcnt lgkmcnt(8)
  s_nop 0
  ds_read_b128 a[232:235], v2 offset:10240
  ds_read_b64_tr_b16 a[106:107], v28 offset:59392
  ds_read_b64_tr_b16 a[108:109], v28 offset:61440
  v_bitop3_b32 v44, v44, v45, s48 bitop3:0x7e
  v_bitop3_b32 v46, v46, v47, s48 bitop3:0x7e
  v_bitop3_b32 v48, v48, v49, s48 bitop3:0x7e
  v_fma_f32 v40, v40, v80, s50
  v_mfma_f32_32x32x16_bf16 v[96:111], a[48:51], a[248:251], v[96:111]
  s_waitcnt lgkmcnt(9)
  ds_read_b128 a[236:239], v2 offset:11264
  ds_read_b64_tr_b16 a[110:111], v28 offset:63488
  v_bitop3_b32 v50, v50, v51, s48 bitop3:0x7e
  v_or3_b32 v44, v44, v46, v48
  v_bitop3_b32 v44, v44, v50, v27 bitop3:0xa8
  v_cmp_ne_u32 vcc, 0, v44
  v_fma_f32 v41, v41, v81, s50
  v_mfma_f32_32x32x16_bf16 v[96:111], a[56:59], a[252:255], v[96:111]
  s_waitcnt lgkmcnt(6)
  ds_read_b128 a[240:243], v2 offset:12288
  v_cvt_pk_bf16_f32 v32, v40, v41
  v_fma_f32 v42, v82, v82, s10
  v_mul_f32 v42, v42, v82
  v_exp_f32 v42, v42
  v_fma_f32 v43, v83, v83, s10
  v_mfma_f32_32x32x16_bf16 v[96:111], a[64:67], a[224:227], v[96:111]
  s_cbranch_vccnz L_x9retry
L_x9ok:
  s_barrier
  ds_read_b128 a[244:247], v2 offset:13312
  buffer_load_dword v4, v17, s[36:39], s60 offen sc1
  v_mul_f32 v43, v43, v83
  v_exp_f32 v43, v43
  v_fma_f32 v42, v42, s49, s49
  v_fma_f32 v43, v43, s49, s49
  v_mfma_f32_32x32x16_bf16 v[96:111], a[72:75], a[228:231], v[96:111]
  s_waitcnt lgkmcnt(6)
  ds_read_b128 a[248:251], v3 offset:0
  v_rcp_f32 v42, v42
  v_rcp_f32 v43, v43
  v_fma_f32 v42, v42, v82, s50
  v_fma_f32 v43, v43, v83, s50
  v_mfma_f32_32x32x16_bf16 v[96:111], a[80:83], a[232:235], v[96:111]
  s_waitcnt lgkmcnt(4)
  ds_read_b128 a[252:255], v3 offset:1024
  buffer_load_dword v5, v17, s[36:39], s61 offen sc1
  v_cvt_pk_bf16_f32 v33, v42, v43
  s_xor_b32 s69, s68, 786432
  v_fma_f32 v40, v84, v84, s10
  v_mul_f32 v40, v40, v84
  v_fma_f32 v41, v85, v85, s10
  v_mfma_f32_32x32x16_bf16 v[96:111], a[88:91], a[236:239], v[96:111]
  s_waitcnt lgkmcnt(3)
  ds_read_b128 a[224:227], v3 offset:2048
  buffer_load_dword v6, v17, s[36:39], s62 offen sc1
  v_exp_f32 v40, v40
  v_mul_f32 v41, v41, v85
  v_exp_f32 v41, v41
  v_mfma_f32_32x32x16_bf16 v[96:111], a[96:99], a[240:243], v[96:111]
  s_waitcnt lgkmcnt(3)
  ds_read_b128 a[228:231], v3 offset:3072
  v_fma_f32 v40, v40, s49, s49
  v_rcp_f32 v40, v40
  v_fma_f32 v41, v41, s49, s49
  v_rcp_f32 v41, v41
  v_fma_f32 v40, v40, v84, s50
  v_mfma_f32_32x32x16_bf16 v[96:111], a[104:107], a[244:247], v[96:111]
  s_waitcnt lgkmcnt(2)
  ds_read_b128 a[232:235], v3 offset:4096
  buffer_load_dword v7, v17, s[36:39], s63 offen sc1
  v_fma_f32 v41, v41, v85, s50
  v_cvt_pk_bf16_f32 v34, v40, v41
  v_fma_f32 v42, v86, v86, s10
  v_mul_f32 v42, v42, v86
  v_fma_f32 v43, v87, v87, s10
  v_mfma_f32_32x32x16_bf16 v[96:111], a[4:7], a[248:251], v[96:111]
  s_waitcnt vmcnt(11)
  ds_read_b128 a[236:239], v3 offset:5120
  ds_read2st64_b64 v[44:47], v13 offset0:32 offset1:34
  buffer_load_dword v18, v17, s[36:39], s64 offen sc1
  v_exp_f32 v42, v42
  v_mul_f32 v43, v43, v87
  v_fma_f32 v42, v42, s49, s49
  v_mfma_f32_32x32x16_bf16 v[96:111], a[12:15], a[252:255], v[96:111]
  s_waitcnt lgkmcnt(4)
  ds_read_b128 a[240:243], v3 offset:6144
  ds_read2st64_b64 v[48:51], v13 offset0:36 offset1:38
  v_exp_f32 v43, v43
  v_rcp_f32 v42, v42
  v_fma_f32 v43, v43, s49, s49
  v_mfma_f32_32x32x16_bf16 v[96:111], a[20:23], a[224:227], v[96:111]
  s_waitcnt lgkmcnt(5)
  ds_read_b128 a[244:247], v3 offset:7168
  buffer_load_dword v19, v17, s[36:39], s65 offen sc1
  v_rcp_f32 v43, v43
  v_fma_f32 v42, v42, v86, s50
  v_fma_f32 v43, v43, v87, s50
  v_cvt_pk_bf16_f32 v35, v42, v43
  v_fma_f32 v40, v88, v88, s10
  v_mfma_f32_32x32x16_bf16 v[96:111], a[28:31], a[228:231], v[96:111]
  s_waitcnt lgkmcnt(4)
  ds_read_b128 a[248:251], v3 offset:8192
  buffer_load_dword v25, v17, s[36:39], s66 offen sc1
  buffer_store_dwordx4 v[32:35], v2, s[36:39], s69 offen sc1
  v_mfma_f32_32x32x16_bf16 v[96:111], a[36:39], a[232:235], v[96:111]
  s_waitcnt vmcnt(19)
  ds_read_b128 a[252:255], v3 offset:9216
  s_add_u32 m0, s71, 32768
  v_mul_f32 v40, v40, v88
  v_exp_f32 v40, v40
  v_fma_f32 v41, v89, v89, s10
  v_mul_f32 v41, v41, v89
  v_mfma_f32_32x32x16_bf16 v[96:111], a[44:47], a[236:239], v[96:111]
  s_waitcnt lgkmcnt(4)
  ds_read_b128 a[224:227], v3 offset:10240
  s_xor_b32 s78, s70, 524288
  buffer_load_dwordx4 v2, s[36:39], s78 offen offset:0 sc1 lds
  buffer_load_dword v26, v17, s[36:39], s67 offen sc1
  s_waitcnt lgkmcnt(4)
  v_bitop3_b32 v44, v44, v45, s48 bitop3:0x7e
  v_bitop3_b32 v46, v46, v47, s48 bitop3:0x7e
  v_bitop3_b32 v48, v48, v49, s48 bitop3:0x7e
  v_fma_f32 v40, v40, s49, s49
  v_mfma_f32_32x32x16_bf16 v[96:111], a[52:55], a[240:243], v[96:111]
  s_waitcnt lgkmcnt(3)
  ds_read_b128 a[228:231], v3 offset:11264
  buffer_load_dwordx4 v2, s[36:39], s78 offen offset:1024 sc1 lds
  v_bitop3_b32 v50, v50, v51, s48 bitop3:0x7e
  v_or3_b32 v44, v44, v46, v48
  v_bitop3_b32 v44, v44, v50, v27 bitop3:0xa8
  v_cmp_ne_u32 vcc, 0, v44
  v_exp_f32 v41, v41
  v_mfma_f32_32x32x16_bf16 v[96:111], a[60:63], a[244:247], v[96:111]
  s_waitcnt lgkmcnt(2)
  ds_read_b128 a[232:235], v3 offset:12288
  buffer_load_dwordx4 v2, s[36:39], s78 offen offset:2048 sc1 lds
  buffer_load_dwordx4 v2, s[36:39], s78 offen offset:3072 sc1 lds
  v_rcp_f32 v40, v40
  v_fma_f32 v41, v41, s49, s49
  v_fma_f32 v40, v40, v88, s50
  v_mfma_f32_32x32x16_bf16 v[96:111], a[68:71], a[248:251], v[96:111]
  s_cbranch_vccnz L_x10retry
L_x10ok:
  s_barrier
  ds_read_b128 a[236:239], v3 offset:13312
  global_load_dwordx4 v[192:195], v24, s[30:31] offset:0
  v_rcp_f32 v41, v41
  v_fma_f32 v42, v90, v90, s10
  v_fma_f32 v41, v41, v89, s50
  v_mfma_f32_32x32x16_bf16 v[96:111], a[76:79], a[252:255], v[96:111]
  s_waitcnt lgkmcnt(3)
  ds_read_b128 a[240:243], v3 offset:16384
  global_load_dwordx4 v[196:199], v24, s[30:31] offset:16
  v_cvt_pk_bf16_f32 v36, v40, v41
  v_mul_f32 v42, v42, v90
  v_exp_f32 v42, v42
  v_fma_f32 v43, v91, v91, s10
  v_mfma_f32_32x32x16_bf16 v[96:111], a[84:87], a[224:227], v[96:111]
  s_waitcnt lgkmcnt(3)
  ds_read_b128 a[244:247], v3 offset:17408
  v_mul_f32 v43, v43, v91
  v_exp_f32 v43, v43
  v_fma_f32 v42, v42, s49, s49
  v_rcp_f32 v42, v42
  v_fma_f32 v43, v43, s49, s49
  v_mfma_f32_32x32x16_bf16 v[96:111], a[92:95], a[228:231], v[96:111]
  s_waitcnt lgkmcnt(3)
  ds_read_b128 a[248:251], v3 offset:18432
  v_rcp_f32 v43, v43
  v_fma_f32 v42, v42, v90, s50
  v_fma_f32 v43, v43, v91, s50
  v_cvt_pk_bf16_f32 v37, v42, v43
  s_xor_b32 s69, s68, 819200
  v_mfma_f32_32x32x16_bf16 v[96:111], a[100:103], a[232:235], v[96:111]
  s_waitcnt lgkmcnt(3)
  ds_read_b128 a[252:255], v3 offset:19456
  v_fma_f32 v40, v92, v92, s10
  v_mul_f32 v40, v40, v92
  v_exp_f32 v40, v40
  v_fma_f32 v41, v93, v93, s10
  v_mul_f32 v41, v41, v93
  v_mfma_f32_32x32x16_bf16 v[96:111], a[108:111], a[236:239], v[96:111]
  s_waitcnt lgkmcnt(2)
  ds_read_b128 a[224:227], v3 offset:20480
  v_exp_f32 v41, v41
  v_fma_f32 v40, v40, s49, s49
  v_rcp_f32 v40, v40
  v_fma_f32 v41, v41, s49, s49
  v_mfma_f32_32x32x16_bf16 v[112:127], a[0:3], a[240:243], 0
  s_waitcnt vmcnt(15)
  ds_read_b128 a[228:231], v3 offset:21504
  ds_read2st64_b64 v[44:47], v12 offset0:32 offset1:34
  v_rcp_f32 v41, v41
  v_fma_f32 v40, v40, v92, s50
  v_fma_f32 v41, v41, v93, s50
  v_cvt_pk_bf16_f32 v38, v40, v41
  v_fma_f32 v42, v94, v94, s10
  v_mfma_f32_32x32x16_bf16 v[112:127], a[8:11], a[244:247], v[112:127]
  s_waitcnt lgkmcnt(4)
  ds_read_b128 a[232:235], v3 offset:22528
  ds_read2st64_b64 v[48:51], v12 offset0:36 offset1:38
  v_mul_f32 v42, v42, v94
  v_exp_f32 v42, v42
  v_fma_f32 v43, v95, v95, s10
  v_mul_f32 v43, v43, v95
  v_mfma_f32_32x32x16_bf16 v[112:127], a[16:19], a[248:251], v[112:127]
  s_waitcnt lgkmcnt(4)
  ds_read_b128 a[236:239], v3 offset:23552
  v_exp_f32 v43, v43
  v_fma_f32 v42, v42, s49, s49
  v_rcp_f32 v42, v42
  v_fma_f32 v43, v43, s49, s49
  v_mfma_f32_32x32x16_bf16 v[112:127], a[24:27], a[252:255], v[112:127]
  s_waitcnt vmcnt(19)
  ds_read_b128 a[240:243], v3 offset:24576
  s_add_u32 m0, s71, 0
  v_rcp_f32 v43, v43
  v_fma_f32 v42, v42, v94, s50
  v_fma_f32 v43, v43, v95, s50
  v_cvt_pk_bf16_f32 v39, v42, v43
  v_mfma_f32_32x32x16_bf16 v[112:127], a[32:35], a[224:227], v[112:127]
  s_waitcnt lgkmcnt(3)
  s_nop 0
  ds_read_b128 a[244:247], v3 offset:25600
  s_xor_b32 s78, s70, 557056
  buffer_load_dwordx4 v2, s[36:39], s78 offen offset:0 sc1 lds
  buffer_store_dwordx4 v[36:39], v2, s[36:39], s69 offen sc1
  v_fma_f32 v96, v96, v11, s50
  v_fma_f32 v97, v97, v11, s50
  v_cvt_pk_bf16_f32 v152, v96, v97
  v_fma_f32 v98, v98, v11, s50
  v_fma_f32 v99, v99, v11, s50
  v_mfma_f32_32x32x16_bf16 v[112:127], a[40:43], a[228:231], v[112:127]
  s_waitcnt lgkmcnt(3)
  s_nop 0
  ds_read_b128 a[248:251], v3 offset:26624
  buffer_load_dwordx4 v2, s[36:39], s78 offen offset:1024 sc1 lds
  v_bitop3_b32 v44, v44, v45, s48 bitop3:0x7e
  v_bitop3_b32 v46, v46, v47, s48 bitop3:0x7e
  v_bitop3_b32 v48, v48, v49, s48 bitop3:0x7e
  v_cvt_pk_bf16_f32 v153, v98, v99
  v_fma_f32 v100, v100, v11, s50
  v_fma_f32 v101, v101, v11, s50
  v_cvt_pk_bf16_f32 v154, v100, v101
  v_fma_f32 v102, v102, v11, s50
  v_mfma_f32_32x32x16_bf16 v[112:127], a[48:51], a[232:235], v[112:127]
  s_waitcnt lgkmcnt(3)
  ds_read_b128 a[252:255], v3 offset:27648
  buffer_load_dwordx4 v2, s[36:39], s78 offen offset:2048 sc1 lds
  buffer_load_dwordx4 v2, s[36:39], s78 offen offset:3072 sc1 lds
  v_bitop3_b32 v50, v50, v51, s48 bitop3:0x7e
  v_or3_b32 v44, v44, v46, v48
  v_bitop3_b32 v44, v44, v50, v27 bitop3:0xa8
  v_cmp_ne_u32 vcc, 0, v44
  v_fma_f32 v103, v103, v11, s50
  v_cvt_pk_bf16_f32 v155, v102, v103
  v_fma_f32 v104, v104, v11, s50
  v_fma_f32 v105, v105, v11, s50
  v_mfma_f32_32x32x16_bf16 v[112:127], a[56:59], a[236:239], v[112:127]
  s_waitcnt lgkmcnt(2)
  s_nop 0
  ds_read_b128 a[224:227], v3 offset:28672
  v_cvt_pk_bf16_f32 v156, v104, v105
  v_fma_f32 v106, v106, v11, s50
  v_fma_f32 v107, v107, v11, s50
  v_cvt_pk_bf16_f32 v157, v106, v107
  v_fma_f32 v108, v108, v11, s50
  v_mfma_f32_32x32x16_bf16 v[112:127], a[64:67], a[240:243], v[112:127]
  s_cbranch_vccnz L_x11retry
L_x11ok:
  s_barrier
  ds_read_b128 a[228:231], v3 offset:29696
  v_fma_f32 v109, v109, v11, s50
  v_cvt_pk_bf16_f32 v158, v108, v109
  v_fma_f32 v110, v110, v11, s50
  v_fma_f32 v111, v111, v11, s50
  v_cvt_pk_bf16_f32 v159, v110, v111
  v_mfma_f32_32x32x16_bf16 v[112:127], a[72:75], a[244:247], v[112:127]
  s_waitcnt lgkmcnt(2)
  ds_read_b128 a[232:235], v2 offset:16384
  v_mfma_f32_32x32x16_bf16 v[112:127], a[80:83], a[248:251], v[112:127]
  s_xor_b32 s73, s72, 458752
  ds_read_b128 a[236:239], v2 offset:17408
  buffer_store_dwordx4 v[152:155], v2, s[36:39], s73 offen offset:0 sc1
  v_mfma_f32_32x32x16_bf16 v[112:127], a[88:91], a[252:255], v[112:127]
  s_waitcnt lgkmcnt(3)
  ds_read_b128 a[240:243], v2 offset:18432
  v_mfma_f32_32x32x16_bf16 v[112:127], a[96:99], a[224:227], v[112:127]
  s_waitcnt lgkmcnt(3)
  ds_read_b128 a[244:247], v2 offset:19456
  v_mfma_f32_32x32x16_bf16 v[112:127], a[104:107], a[228:231], v[112:127]
  s_waitcnt lgkmcnt(2)
  ds_read_b128 a[248:251], v2 offset:20480
  v_mfma_f32_32x32x16_bf16 v[112:127], a[4:7], a[232:235], v[112:127]
  s_waitcnt vmcnt(8)
  ds_read_b128 a[252:255], v2 offset:21504
  ds_read2st64_b64 v[44:47], v12 offset0:64 offset1:66
  buffer_store_dwordx4 v[156:159], v2, s[36:39], s73 offen offset:1024 sc1
  v_mfma_f32_32x32x16_bf16 v[112:127], a[12:15], a[236:239], v[112:127]
  s_waitcnt lgkmcnt(4)
  ds_read_b128 a[224:227], v2 offset:22528
  ds_read2st64_b64 v[48:51], v12 offset0:68 offset1:70
  v_mfma_f32_32x32x16_bf16 v[112:127], a[20:23], a[240:243], v[112:127]
  s_waitcnt lgkmcnt(5)
  ds_read_b128 a[228:231], v2 offset:23552
  v_mfma_f32_32x32x16_bf16 v[112:127], a[28:31], a[244:247], v[112:127]
  s_waitcnt lgkmcnt(5)
  ds_read_b128 a[232:235], v2 offset:24576
  v_mfma_f32_32x32x16_bf16 v[112:127], a[36:39], a[248:251], v[112:127]
  s_waitcnt lgkmcnt(3)
  ds_read_b128 a[236:239], v2 offset:25600
  v_mfma_f32_32x32x16_bf16 v[112:127], a[44:47], a[252:255], v[112:127]
  s_waitcnt lgkmcnt(3)
  ds_read_b128 a[240:243], v2 offset:26624
  v_bitop3_b32 v44, v44, v45, s48 bitop3:0x7e
  v_bitop3_b32 v46, v46, v47, s48 bitop3:0x7e
  v_bitop3_b32 v48, v48, v49, s48 bitop3:0x7e
  v_mfma_f32_32x32x16_bf16 v[112:127], a[52:55], a[224:227], v[112:127]
  s_waitcnt lgkmcnt(2)
  ds_read_b128 a[244:247], v2 offset:27648
  s_waitcnt vmcnt(14)
  s_add_u32 m0, s71, 49152
  v_bitop3_b32 v50, v50, v51, s48 bitop3:0x7e
  v_or3_b32 v44, v44, v46, v48
  v_bitop3_b32 v44, v44, v50, v27 bitop3:0xa8
  v_cmp_ne_u32 vcc, 0, v44
  v_mfma_f32_32x32x16_bf16 v[112:127], a[60:63], a[228:231], v[112:127]
  s_xor_b32 s78, s70, 786432
  ds_read_b128 a[248:251], v2 offset:28672
  buffer_load_dwordx4 v2, s[36:39], s78 offen offset:0 sc1 lds
  v_mfma_f32_32x32x16_bf16 v[112:127], a[68:71], a[232:235], v[112:127]
  s_cbranch_vccnz L_x12retry
L_x12ok:
  s_barrier
  s_waitcnt lgkmcnt(3)
  ds_read_b128 a[252:255], v2 offset:29696
  buffer_load_dwordx4 v2, s[36:39], s78 offen offset:1024 sc1 lds
  v_mfma_f32_32x32x16_bf16 v[112:127], a[76:79], a[236:239], v[112:127]
  s_waitcnt lgkmcnt(3)
  ds_read_b128 a[224:227], v2 offset:32768
  buffer_load_dwordx4 v2, s[36:39], s78 offen offset:2048 sc1 lds
  buffer_load_dwordx4 v2, s[36:39], s78 offen offset:3072 sc1 lds
  v_mfma_f32_32x32x16_bf16 v[112:127], a[84:87], a[240:243], v[112:127]
  s_waitcnt lgkmcnt(3)
  ds_read_b128 a[228:231], v2 offset:33792
  v_mfma_f32_32x32x16_bf16 v[112:127], a[92:95], a[244:247], v[112:127]
  s_waitcnt lgkmcnt(3)
  ds_read_b128 a[232:235], v2 offset:34816
  v_mfma_f32_32x32x16_bf16 v[112:127], a[100:103], a[248:251], v[112:127]
  s_waitcnt lgkmcnt(3)
  ds_read_b128 a[236:239], v2 offset:35840
L_hop77:
  s_cbranch_execz L_wb2
  s_waitcnt vmcnt(11)
  v_lshlrev_b32 v216, 16, v4
  v_and_b32 v217, 0xffff0000, v4
  v_lshlrev_b32 v218, 16, v20
  v_and_b32 v219, 0xffff0000, v20
  v_mfma_f32_32x32x16_bf16 v[112:127], a[108:111], a[252:255], v[112:127]
  s_waitcnt lgkmcnt(2)
  ds_read_b128 a[240:243], v2 offset:36864
  v_fma_f32 v216, v216, s49, v218
  v_fma_f32 v217, v217, s49, v219
  v_cvt_pk_bf16_f32 v216, v216, v217
  v_lshlrev_b32 v218, 16, v192
  v_and_b32 v219, 0xffff0000, v192
  v_mfma_f32_32x32x16_bf16 v[96:111], a[0:3], a[224:227], 0
  s_waitcnt vmcnt(6)
  ds_read_b128 a[244:247], v2 offset:37888
  ds_read2st64_b64 v[44:47], v12 offset0:0 offset1:2
  v_and_b32 v217, 0xffff0000, v216
  v_lshlrev_b32 v216, 16, v216
  v_add_f32 v200, v216, v218
  v_add_f32 v201, v217, v219
  v_mfma_f32_32x32x16_bf16 v[96:111], a[8:11], a[228:231], v[96:111]
  s_waitcnt lgkmcnt(4)
  ds_read_b128 a[248:251], v2 offset:38912
  ds_read2st64_b64 v[48:51], v12 offset0:4 offset1:6
  v_lshlrev_b32 v216, 16, v5
  v_and_b32 v217, 0xffff0000, v5
  v_lshlrev_b32 v218, 16, v21
  v_and_b32 v219, 0xffff0000, v21
  v_mfma_f32_32x32x16_bf16 v[96:111], a[16:19], a[232:235], v[96:111]
  s_waitcnt lgkmcnt(5)
  ds_read_b128 a[252:255], v2 offset:39936
  v_fma_f32 v112, v112, v11, s50
  v_fma_f32 v113, v113, v11, s50
  v_cvt_pk_bf16_f32 v160, v112, v113
  v_fma_f32 v114, v114, v11, s50
  v_fma_f32 v115, v115, v11, s50
  v_mfma_f32_32x32x16_bf16 v[96:111], a[24:27], a[236:239], v[96:111]
  s_waitcnt lgkmcnt(5)
  s_nop 0
  ds_read_b128 a[224:227], v2 offset:40960
  v_cvt_pk_bf16_f32 v161, v114, v115
  v_fma_f32 v116, v116, v11, s50
  v_fma_f32 v117, v117, v11, s50
  v_cvt_pk_bf16_f32 v162, v116, v117
  v_fma_f32 v118, v118, v11, s50
  v_mfma_f32_32x32x16_bf16 v[96:111], a[32:35], a[240:243], v[96:111]
  s_waitcnt lgkmcnt(3)
  s_nop 0
  ds_read_b128 a[228:231], v2 offset:41984
  v_fma_f32 v119, v119, v11, s50
  v_cvt_pk_bf16_f32 v163, v118, v119
  v_fma_f32 v120, v120, v11, s50
  v_fma_f32 v121, v121, v11, s50
  v_fma_f32 v216, v216, s49, v218
  v_mfma_f32_32x32x16_bf16 v[96:111], a[40:43], a[244:247], v[96:111]
  s_waitcnt lgkmcnt(3)
  s_nop 0
  ds_read_b128 a[232:235], v2 offset:43008
  s_xor_b32 s73, s72, 655360
  buffer_store_dwordx4 v[160:163], v2, s[36:39], s73 offen offset:0 sc1
  v_bitop3_b32 v44, v44, v45, s48 bitop3:0x7e
  v_bitop3_b32 v46, v46, v47, s48 bitop3:0x7e
  v_bitop3_b32 v48, v48, v49, s48 bitop3:0x7e
  v_cvt_pk_bf16_f32 v164, v120, v121
  v_fma_f32 v122, v122, v11, s50
  v_fma_f32 v123, v123, v11, s50
  v_cvt_pk_bf16_f32 v165, v122, v123
  v_fma_f32 v124, v124, v11, s50
  v_mfma_f32_32x32x16_bf16 v[96:111], a[48:51], a[248:251], v[96:111]
  s_waitcnt lgkmcnt(2)
  ds_read_b128 a[236:239], v2 offset:44032
  s_waitcnt vmcnt(10)
  s_add_u32 m0, s71, 65536
  v_bitop3_b32 v50, v50, v51, s48 bitop3:0x7e
  v_or3_b32 v44, v44, v46, v48
  v_bitop3_b32 v44, v44, v50, v27 bitop3:0xa8
  v_cmp_ne_u32 vcc, 0, v44
  s_nop 0
  v_fma_f32 v125, v125, v11, s50
  v_cvt_pk_bf16_f32 v166, v124, v125
  v_fma_f32 v126, v126, v11, s50
  v_fma_f32 v127, v127, v11, s50
  v_cvt_pk_bf16_f32 v167, v126, v127
  v_mfma_f32_32x32x16_bf16 v[96:111], a[56:59], a[252:255], v[96:111]
  s_xor_b32 s78, s70, 819200
  ds_read_b128 a[240:243], v2 offset:45056
  buffer_load_dwordx4 v2, s[36:39], s78 offen offset:0 sc1 lds
  v_fma_f32 v217, v217, s49, v219
  v_cvt_pk_bf16_f32 v216, v216, v217
  v_lshlrev_b32 v218, 16, v193
  v_and_b32 v219, 0xffff0000, v193
  v_mfma_f32_32x32x16_bf16 v[96:111], a[64:67], a[224:227], v[96:111]
  s_cbranch_vccnz L_x13retry
L_x13ok:
  s_barrier
  s_waitcnt lgkmcnt(3)
  ds_read_b128 a[244:247], v2 offset:46080
  buffer_load_dwordx4 v2, s[36:39], s78 offen offset:1024 sc1 lds
  v_and_b32 v217, 0xffff0000, v216
  v_lshlrev_b32 v216, 16, v216
  v_mfma_f32_32x32x16_bf16 v[96:111], a[72:75], a[228:231], v[96:111]
  s_waitcnt lgkmcnt(3)
  ds_read_b128 a[248:251], v2 offset:0
  buffer_load_dwordx4 v2, s[36:39], s78 offen offset:2048 sc1 lds
  buffer_load_dwordx4 v2, s[36:39], s78 offen offset:3072 sc1 lds
  v_add_f32 v202, v216, v218
  v_add_f32 v203, v217, v219
  v_lshlrev_b32 v216, 16, v6
  v_mfma_f32_32x32x16_bf16 v[96:111], a[80:83], a[232:235], v[96:111]
  s_waitcnt lgkmcnt(3)
  ds_read_b128 a[252:255], v2 offset:1024
  v_and_b32 v217, 0xffff0000, v6
  v_lshlrev_b32 v218, 16, v22
  v_and_b32 v219, 0xffff0000, v22
  v_fma_f32 v216, v216, s49, v218
  v_fma_f32 v217, v217, s49, v219
  v_mfma_f32_32x32x16_bf16 v[96:111], a[88:91], a[236:239], v[96:111]
  s_waitcnt lgkmcnt(3)
  ds_read_b128 a[224:227], v2 offset:2048
  v_cvt_pk_bf16_f32 v216, v216, v217
  v_lshlrev_b32 v218, 16, v194
  v_and_b32 v219, 0xffff0000, v194
  v_and_b32 v217, 0xffff0000, v216
  v_lshlrev_b32 v216, 16, v216
  v_mfma_f32_32x32x16_bf16 v[96:111], a[96:99], a[240:243], v[96:111]
  s_waitcnt lgkmcnt(3)
  ds_read_b128 a[228:231], v2 offset:3072
  v_add_f32 v204, v216, v218
  v_add_f32 v205, v217, v219
  v_lshlrev_b32 v216, 16, v7
  v_and_b32 v217, 0xffff0000, v7
  v_lshlrev_b32 v218, 16, v23
  v_mfma_f32_32x32x16_bf16 v[96:111], a[104:107], a[244:247], v[96:111]
  s_waitcnt lgkmcnt(2)
  ds_read_b128 a[232:235], v2 offset:4096
  buffer_store_dwordx4 v[164:167], v2, s[36:39], s73 offen offset:1024 sc1
  v_mfma_f32_32x32x16_bf16 v[96:111], a[4:7], a[248:251], v[96:111]
  s_waitcnt vmcnt(6)
  s_nop 0
  ds_read_b128 a[236:239], v2 offset:5120
  ds_read2st64_b64 v[44:47], v12 offset0:96 offset1:98
  v_and_b32 v219, 0xffff0000, v23
  v_fma_f32 v216, v216, s49, v218
  v_fma_f32 v217, v217, s49, v219
  v_cvt_pk_bf16_f32 v216, v216, v217
  v_mfma_f32_32x32x16_bf16 v[96:111], a[12:15], a[252:255], v[96:111]
  s_waitcnt lgkmcnt(4)
  ds_read_b128 a[240:243], v2 offset:6144
  ds_read2st64_b64 v[48:51], v12 offset0:100 offset1:102
  v_lshlrev_b32 v218, 16, v195
  v_and_b32 v219, 0xffff0000, v195
  v_and_b32 v217, 0xffff0000, v216
  v_lshlrev_b32 v216, 16, v216
  v_mfma_f32_32x32x16_bf16 v[96:111], a[20:23], a[224:227], v[96:111]
  s_waitcnt lgkmcnt(5)
  ds_read_b128 a[244:247], v2 offset:7168
  v_add_f32 v206, v216, v218
  v_add_f32 v207, v217, v219
  v_lshlrev_b32 v216, 16, v18
  v_and_b32 v217, 0xffff0000, v18
  v_lshlrev_b32 v218, 16, v60
  v_mfma_f32_32x32x16_bf16 v[96:111], a[28:31], a[228:231], v[96:111]
  s_waitcnt lgkmcnt(5)
  ds_read_b128 a[248:251], v2 offset:8192
  v_and_b32 v219, 0xffff0000, v60
  v_fma_f32 v216, v216, s49, v218
  v_fma_f32 v217, v217, s49, v219
  v_cvt_pk_bf16_f32 v216, v216, v217
  v_lshlrev_b32 v218, 16, v196
  v_mfma_f32_32x32x16_bf16 v[96:111], a[36:39], a[232:235], v[96:111]
  s_waitcnt lgkmcnt(3)
  ds_read_b128 a[252:255], v2 offset:9216
  v_and_b32 v219, 0xffff0000, v196
  v_and_b32 v217, 0xffff0000, v216
  v_lshlrev_b32 v216, 16, v216
  v_add_f32 v208, v216, v218
  v_add_f32 v209, v217, v219
  v_mfma_f32_32x32x16_bf16 v[96:111], a[44:47], a[236:239], v[96:111]
  s_waitcnt lgkmcnt(3)
  ds_read_b128 a[224:227], v2 offset:10240
  v_bitop3_b32 v44, v44, v45, s48 bitop3:0x7e
  v_bitop3_b32 v46, v46, v47, s48 bitop3:0x7e
  v_bitop3_b32 v48, v48, v49, s48 bitop3:0x7e
  v_lshlrev_b32 v216, 16, v19
  v_and_b32 v217, 0xffff0000, v19
  v_mfma_f32_32x32x16_bf16 v[96:111], a[52:55], a[240:243], v[96:111]
  s_waitcnt lgkmcnt(3)
  ds_read_b128 a[228:231], v2 offset:11264
  v_bitop3_b32 v50, v50, v51, s48 bitop3:0x7e
  v_or3_b32 v44, v44, v46, v48
  v_bitop3_b32 v44, v44, v50, v27 bitop3:0xa8
  v_cmp_ne_u32 vcc, 0, v44
  v_lshlrev_b32 v218, 16, v61
  v_mfma_f32_32x32x16_bf16 v[96:111], a[60:63], a[244:247], v[96:111]
  s_waitcnt lgkmcnt(2)
  ds_read_b128 a[232:235], v2 offset:12288
  v_and_b32 v219, 0xffff0000, v61
  v_fma_f32 v216, v216, s49, v218
  v_fma_f32 v217, v217, s49, v219
  v_cvt_pk_bf16_f32 v216, v216, v217
  v_lshlrev_b32 v218, 16, v197
  v_mfma_f32_32x32x16_bf16 v[96:111], a[68:71], a[248:251], v[96:111]
  s_cbranch_vccnz L_x14retry
L_x14ok:
  s_barrier
  ds_read_b128 a[236:239], v2 offset:13312
  v_and_b32 v219, 0xffff0000, v197
  v_and_b32 v217, 0xffff0000, v216
  v_lshlrev_b32 v216, 16, v216
  v_add_f32 v210, v216, v218
  v_mfma_f32_32x32x16_bf16 v[96:111], a[76:79], a[252:255], v[96:111]
  s_waitcnt lgkmcnt(3)
  ds_read_b128 a[240:243], v2 offset:49152
  v_add_f32 v211, v217, v219
  v_lshlrev_b32 v216, 16, v25
  v_and_b32 v217, 0xffff0000, v25
  v_lshlrev_b32 v218, 16, v62
  v_and_b32 v219, 0xffff0000, v62
  v_mfma_f32_32x32x16_bf16 v[96:111], a[84:87], a[224:227], v[96:111]
  s_waitcnt lgkmcnt(3)
  ds_read_b128 a[244:247], v2 offset:50176
  v_fma_f32 v216, v216, s49, v218
  v_fma_f32 v217, v217, s49, v219
  v_cvt_pk_bf16_f32 v216, v216, v217
  v_lshlrev_b32 v218, 16, v198
  v_and_b32 v219, 0xffff0000, v198
  v_mfma_f32_32x32x16_bf16 v[96:111], a[92:95], a[228:231], v[96:111]
  s_waitcnt lgkmcnt(3)
  ds_read_b128 a[248:251], v2 offset:51200
  v_and_b32 v217, 0xffff0000, v216
  v_lshlrev_b32 v216, 16, v216
  v_add_f32 v212, v216, v218
  v_add_f32 v213, v217, v219
  v_lshlrev_b32 v216, 16, v26
  v_mfma_f32_32x32x16_bf16 v[96:111], a[100:103], a[232:235], v[96:111]
  s_waitcnt lgkmcnt(3)
  ds_read_b128 a[252:255], v2 offset:52224
  v_and_b32 v217, 0xffff0000, v26
  v_lshlrev_b32 v218, 16, v63
  v_and_b32 v219, 0xffff0000, v63
  v_fma_f32 v216, v216, s49, v218
  v_fma_f32 v217, v217, s49, v219
  v_mfma_f32_32x32x16_bf16 v[96:111], a[108:111], a[236:239], v[96:111]
  s_waitcnt lgkmcnt(2)
  ds_read_b128 a[224:227], v2 offset:53248
  v_cvt_pk_bf16_f32 v216, v216, v217
  v_lshlrev_b32 v218, 16, v199
  v_and_b32 v219, 0xffff0000, v199
  v_and_b32 v217, 0xffff0000, v216
  v_lshlrev_b32 v216, 16, v216
  v_mfma_f32_32x32x16_bf16 v[112:127], a[0:3], a[240:243], 0
  s_waitcnt vmcnt(1)
  ds_read_b128 a[228:231], v2 offset:54272
  ds_read2st64_b64 v[44:47], v13 offset0:0 offset1:2
  v_add_f32 v214, v216, v218
  v_add_f32 v215, v217, v219
  v_mfma_f32_32x32x16_bf16 v[112:127], a[8:11], a[244:247], v[112:127]
  s_waitcnt lgkmcnt(3)
  s_nop 0
  ds_read_b128 a[232:235], v2 offset:55296
  ds_read2st64_b64 v[48:51], v13 offset0:4 offset1:6
  v_fma_f32 v96, v96, v30, s57
  v_fma_f32 v97, v97, v30, s57
  v_cvt_pk_bf16_f32 v168, v96, v97
  v_fma_f32 v98, v98, v30, s57
  v_fma_f32 v99, v99, v30, s57
  v_cvt_pk_bf16_f32 v169, v98, v99
  v_mfma_f32_32x32x16_bf16 v[112:127], a[16:19], a[248:251], v[112:127]
  s_add_u32 s79, s72, 262144
  ds_read_b128 a[236:239], v2 offset:56320
  buffer_load_dwordx4 v[128:131], v2, s[36:39], s79 offen offset:0 sc1
  v_fma_f32 v100, v100, v30, s57
  v_fma_f32 v101, v101, v30, s57
  v_cvt_pk_bf16_f32 v170, v100, v101
  v_fma_f32 v102, v102, v30, s57
  v_fma_f32 v103, v103, v30, s57
  v_cvt_pk_bf16_f32 v171, v102, v103
  v_mfma_f32_32x32x16_bf16 v[112:127], a[24:27], a[252:255], v[112:127]
  s_waitcnt lgkmcnt(5)
  s_nop 0
  ds_read_b128 a[240:243], v2 offset:57344
  buffer_store_dwordx4 v[168:171], v2, s[36:39], s74 offen offset:0 sc1
  buffer_load_dwordx4 v[132:135], v2, s[36:39], s79 offen offset:1024 sc1
  v_fma_f32 v104, v104, v30, s57
  v_fma_f32 v105, v105, v30, s57
  v_cvt_pk_bf16_f32 v172, v104, v105
  v_fma_f32 v106, v106, v30, s57
  v_fma_f32 v107, v107, v30, s57
  v_cvt_pk_bf16_f32 v173, v106, v107
  v_mfma_f32_32x32x16_bf16 v[112:127], a[32:35], a[224:227], v[112:127]
  s_waitcnt lgkmcnt(3)
  s_nop 0
  ds_read_b128 a[244:247], v2 offset:58368
  v_fma_f32 v108, v108, v30, s57
  v_fma_f32 v109, v109, v30, s57
  v_cvt_pk_bf16_f32 v174, v108, v109
  v_fma_f32 v110, v110, v30, s57
  v_fma_f32 v111, v111, v30, s57
  v_cvt_pk_bf16_f32 v175, v110, v111
  v_mfma_f32_32x32x16_bf16 v[112:127], a[40:43], a[228:231], v[112:127]
  s_waitcnt lgkmcnt(3)
  ds_read_b128 a[248:251], v2 offset:59392
  buffer_store_dwordx4 v[172:175], v2, s[36:39], s74 offen offset:1024 sc1
  v_bitop3_b32 v44, v44, v45, s48 bitop3:0x7e
  v_bitop3_b32 v46, v46, v47, s48 bitop3:0x7e
  v_bitop3_b32 v48, v48, v49, s48 bitop3:0x7e
  v_mfma_f32_32x32x16_bf16 v[112:127], a[48:51], a[232:235], v[112:127]
  s_waitcnt lgkmcnt(3)
  ds_read_b128 a[252:255], v2 offset:60416
  v_bitop3_b32 v50, v50, v51, s48 bitop3:0x7e
  v_or3_b32 v44, v44, v46, v48
  v_bitop3_b32 v44, v44, v50, v27 bitop3:0xa8
  v_cmp_ne_u32 vcc, 0, v44
  v_mfma_f32_32x32x16_bf16 v[112:127], a[56:59], a[236:239], v[112:127]
  s_waitcnt lgkmcnt(2)
  ds_read_b128 a[224:227], v2 offset:61440
  v_mfma_f32_32x32x16_bf16 v[112:127], a[64:67], a[240:243], v[112:127]
  s_cbranch_vccnz L_x15retry
L_x15ok:
  s_barrier
  ds_read_b128 a[228:231], v2 offset:62464
  v_mfma_f32_32x32x16_bf16 v[112:127], a[72:75], a[244:247], v[112:127]
  s_waitcnt lgkmcnt(3)
  ds_read_b128 a[232:235], v3 offset:0
  v_mfma_f32_32x32x16_bf16 v[112:127], a[80:83], a[248:251], v[112:127]
  s_waitcnt lgkmcnt(3)
  ds_read_b128 a[236:239], v3 offset:1024
  v_readfirstlane_b32 s52, v16
  v_lshrrev_b32 v220, 2, v1
  v_and_b32 v221, 3, v1
  v_mfma_f32_32x32x16_bf16 v[112:127], a[88:91], a[252:255], v[112:127]
  s_waitcnt lgkmcnt(3)
  ds_read_b128 a[240:243], v3 offset:2048
  v_lshlrev_b32 v222, 4, v221
  v_lshl_add_u32 v222, v220, 10, v222
  v_add_u32 v222, s52, v222
  v_mfma_f32_32x32x16_bf16 v[112:127], a[96:99], a[224:227], v[112:127]
  s_waitcnt lgkmcnt(3)
  ds_read_b128 a[244:247], v3 offset:3072
  v_add_u32 v223, 0x4000, v222
  s_add_u32 s53, s77, 16384
  v_mfma_f32_32x32x16_bf16 v[112:127], a[104:107], a[228:231], v[112:127]
  s_waitcnt lgkmcnt(3)
  ds_read_b128 a[248:251], v3 offset:4096
  v_bfe_u32 v224, v1, 3, 2
  v_xor_b32 v221, v221, v224
  v_lshlrev_b32 v221, 4, v221
  v_mfma_f32_32x32x16_bf16 v[112:127], a[4:7], a[232:235], v[112:127]
  s_waitcnt lgkmcnt(3)
  ds_read_b128 a[252:255], v3 offset:5120
  v_lshl_add_u32 v221, v220, 6, v221
  v_add_u32 v221, s53, v221
  v_bfe_u32 v224, v1, 1, 2
  v_mfma_f32_32x32x16_bf16 v[112:127], a[12:15], a[236:239], v[112:127]
  s_waitcnt lgkmcnt(3)
  ds_read_b128 a[224:227], v3 offset:6144
  v_lshrrev_b32 v225, 4, v1
  v_and_b32 v225, 2, v225
  v_xor_b32 v224, v224, v225
  v_mfma_f32_32x32x16_bf16 v[112:127], a[20:23], a[240:243], v[112:127]
  s_waitcnt lgkmcnt(3)
  ds_read_b128 a[228:231], v3 offset:7168
  v_and_b32 v225, 31, v1
  v_lshlrev_b32 v225, 6, v225
  v_mfma_f32_32x32x16_bf16 v[112:127], a[28:31], a[244:247], v[112:127]
  s_waitcnt lgkmcnt(3)
  ds_read_b128 a[232:235], v3 offset:8192
  v_lshl_add_u32 v224, v224, 4, v225
  v_add_u32 v224, s53, v224
  v_xor_b32 v225, 16, v224
  v_mfma_f32_32x32x16_bf16 v[112:127], a[36:39], a[248:251], v[112:127]
  s_waitcnt lgkmcnt(3)
  ds_read_b128 a[236:239], v3 offset:9216
  v_mfma_f32_32x32x16_bf16 v[112:127], a[44:47], a[252:255], v[112:127]
  s_waitcnt lgkmcnt(2)
  ds_read_b128 a[240:243], v3 offset:10240
  v_mfma_f32_32x32x16_bf16 v[112:127], a[52:55], a[224:227], v[112:127]
  s_add_u32 s79, s72, 524288
  ds_read_b128 a[244:247], v3 offset:11264
  buffer_load_dwordx4 v[136:139], v2, s[36:39], s79 offen offset:0 sc1
  v_mfma_f32_32x32x16_bf16 v[112:127], a[60:63], a[228:231], v[112:127]
  s_waitcnt lgkmcnt(3)
  ds_read_b128 a[248:251], v3 offset:12288
  buffer_load_dwordx4 v[140:143], v2, s[36:39], s79 offen offset:1024 sc1
  v_mfma_f32_32x32x16_bf16 v[112:127], a[68:71], a[232:235], v[112:127]
  s_waitcnt lgkmcnt(3)
  ds_read_b128 a[252:255], v3 offset:13312
  v_mfma_f32_32x32x16_bf16 v[112:127], a[76:79], a[236:239], v[112:127]
  s_waitcnt lgkmcnt(3)
  v_mfma_f32_32x32x16_bf16 v[112:127], a[84:87], a[240:243], v[112:127]
  s_waitcnt lgkmcnt(2)
  v_mfma_f32_32x32x16_bf16 v[112:127], a[92:95], a[244:247], v[112:127]
  s_waitcnt lgkmcnt(0)
  v_mfma_f32_32x32x16_bf16 v[112:127], a[100:103], a[248:251], v[112:127]
  s_xor_b32 s79, s74, 0x50000
  buffer_load_dwordx4 v[144:147], v2, s[36:39], s79 offen offset:0 sc1
  buffer_load_dwordx4 v[148:151], v2, s[36:39], s79 offen offset:1024 sc1
  v_mfma_f32_32x32x16_bf16 v[112:127], a[108:111], a[252:255], v[112:127]
  s_nop 11
  v_pk_fma_f32 v[112:113], v[112:113], s[50:51], v[200:201] op_sel:[0,1,0] op_sel_hi:[1,1,1]
  s_waitcnt vmcnt(5)
  v_bitop3_b32 v60, v129, v131, s48 bitop3:0x7e
  v_bitop3_b32 v61, v133, v135, s48 bitop3:0x7e
  v_bitop3_b32 v60, v60, v61, v27 bitop3:0xa8
  v_cmp_ne_u32 vcc, 0, v60
  v_pk_fma_f32 v[114:115], v[114:115], s[50:51], v[202:203] op_sel:[0,1,0] op_sel_hi:[1,1,1]
  v_pk_fma_f32 v[116:117], v[116:117], s[50:51], v[204:205] op_sel:[0,1,0] op_sel_hi:[1,1,1]
  v_pk_fma_f32 v[118:119], v[118:119], s[50:51], v[206:207] op_sel:[0,1,0] op_sel_hi:[1,1,1]
  v_pk_fma_f32 v[120:121], v[120:121], s[50:51], v[208:209] op_sel:[0,1,0] op_sel_hi:[1,1,1]
  v_pk_fma_f32 v[122:123], v[122:123], s[50:51], v[210:211] op_sel:[0,1,0] op_sel_hi:[1,1,1]
  v_pk_fma_f32 v[124:125], v[124:125], s[50:51], v[212:213] op_sel:[0,1,0] op_sel_hi:[1,1,1]
  v_pk_fma_f32 v[126:127], v[126:127], s[50:51], v[214:215] op_sel:[0,1,0] op_sel_hi:[1,1,1]
  s_cbranch_vccnz L_p0retry
L_p0ok:
  v_dot2c_f32_bf16 v112, s80, v128
  v_dot2c_f32_bf16 v113, s49, v128
  v_dot2c_f32_bf16 v114, s80, v129
  v_dot2c_f32_bf16 v115, s49, v129
  v_dot2c_f32_bf16 v116, s80, v130
  v_dot2c_f32_bf16 v117, s49, v130
  v_dot2c_f32_bf16 v118, s80, v131
  v_dot2c_f32_bf16 v119, s49, v131
  v_dot2c_f32_bf16 v120, s80, v132
  s_waitcnt vmcnt(2)
  v_bitop3_b32 v60, v137, v139, s48 bitop3:0x7e
  v_bitop3_b32 v61, v141, v143, s48 bitop3:0x7e
  v_bitop3_b32 v60, v60, v61, v27 bitop3:0xa8
  v_cmp_ne_u32 vcc, 0, v60
  v_dot2c_f32_bf16 v121, s49, v132
  v_dot2c_f32_bf16 v122, s80, v133
  v_dot2c_f32_bf16 v123, s49, v133
  v_dot2c_f32_bf16 v124, s80, v134
  v_dot2c_f32_bf16 v125, s49, v134
  v_dot2c_f32_bf16 v126, s80, v135
  v_dot2c_f32_bf16 v127, s49, v135
  s_cbranch_vccnz L_p1retry
L_p1ok:
  v_dot2c_f32_bf16 v112, s80, v136
  v_dot2c_f32_bf16 v113, s49, v136
  v_dot2c_f32_bf16 v114, s80, v137
  v_dot2c_f32_bf16 v115, s49, v137
  v_dot2c_f32_bf16 v116, s80, v138
  v_dot2c_f32_bf16 v117, s49, v138
  v_dot2c_f32_bf16 v118, s80, v139
  v_dot2c_f32_bf16 v119, s49, v139
  v_dot2c_f32_bf16 v120, s80, v140
  s_waitcnt vmcnt(0)
  v_bitop3_b32 v60, v145, v147, s56 bitop3:0x7e
  v_bitop3_b32 v61, v149, v151, s56 bitop3:0x7e
  v_bitop3_b32 v60, v60, v61, v27 bitop3:0xa8
  v_cmp_ne_u32 vcc, 0, v60
  v_dot2c_f32_bf16 v121, s49, v140
  v_dot2c_f32_bf16 v122, s80, v141
  v_dot2c_f32_bf16 v123, s49, v141
  v_dot2c_f32_bf16 v124, s80, v142
  v_dot2c_f32_bf16 v125, s49, v142
  v_dot2c_f32_bf16 v126, s80, v143
  v_dot2c_f32_bf16 v127, s49, v143
  s_cbranch_vccnz L_p2retry
L_p2ok:
  v_dot2c_f32_bf16 v112, s59, v144
  v_dot2c_f32_bf16 v113, s58, v144
  v_dot2c_f32_bf16 v114, s59, v145
  v_dot2c_f32_bf16 v115, s58, v145
  v_dot2c_f32_bf16 v116, s59, v146
  v_dot2c_f32_bf16 v117, s58, v146
  v_dot2c_f32_bf16 v118, s59, v147
  v_dot2c_f32_bf16 v119, s58, v147
  v_dot2c_f32_bf16 v120, s59, v148
  v_dot2c_f32_bf16 v121, s58, v148
  v_dot2c_f32_bf16 v122, s59, v149
  v_cvt_pk_bf16_f32 v32, v112, v113
  v_cvt_pk_bf16_f32 v33, v114, v115
  v_cvt_pk_bf16_f32 v34, v116, v117
  v_cvt_pk_bf16_f32 v35, v118, v119
  ds_write_b128 v224, v[32:35]
  v_dot2c_f32_bf16 v123, s58, v149
  v_dot2c_f32_bf16 v124, s59, v150
  v_dot2c_f32_bf16 v125, s58, v150
  v_dot2c_f32_bf16 v126, s59, v151
  v_dot2c_f32_bf16 v127, s58, v151
  s_nop 0
  v_cvt_pk_bf16_f32 v36, v120, v121
  v_cvt_pk_bf16_f32 v37, v122, v123
  v_cvt_pk_bf16_f32 v38, v124, v125
  v_cvt_pk_bf16_f32 v39, v126, v127
  ds_write_b128 v225, v[36:39]
  ds_read_b128 v[32:35], v221 offset:0
  ds_read_b128 v[36:39], v221 offset:1024
  s_waitcnt lgkmcnt(1)
  global_store_dwordx4 v222, v[32:35], s[32:33] offset:0 sc1
  s_waitcnt lgkmcnt(0)
  global_store_dwordx4 v223, v[36:39], s[32:33] offset:0 sc1
  s_endpgm
L_h1retry:
  s_add_u32 s90, s90, 1
  s_cmp_gt_u32 s90, 20000
  s_cbranch_scc1 L_h1ok
  buffer_load_dwordx4 v[32:35], v14, s[36:39], s97 offen sc1
  buffer_load_dwordx4 v[36:39], v14, s[36:39], s98 offen sc1
  s_waitcnt vmcnt(0)
  s_branch L_h1chk
L_decretry:
  s_add_u32 s90, s90, 1
  s_cmp_gt_u32 s90, 20000
  s_cbranch_scc1 L_decok
  s_mov_b32 s76, 323968
  buffer_load_dword v57, off, s[36:39], s76 sc1
  s_waitcnt vmcnt(0)
  v_readfirstlane_b32 s76, v57
  s_nop 0
  s_sub_u32 s76, s76, s54
  s_cmp_gt_u32 s76, 1
  s_cbranch_scc1 L_decretry
  s_branch L_decok
L_h2retry:
  s_add_u32 s90, s90, 1
  s_cmp_gt_u32 s90, 20000
  s_cbranch_scc1 L_h2ok
  buffer_load_dword v80, v107, s[36:39], s60 offen sc1
  buffer_load_dword v81, v107, s[36:39], s61 offen sc1
  buffer_load_dword v82, v107, s[36:39], s62 offen sc1
  buffer_load_dword v83, v107, s[36:39], s63 offen sc1
  buffer_load_dword v84, v107, s[36:39], s64 offen sc1
  buffer_load_dword v85, v107, s[36:39], s65 offen sc1
  buffer_load_dword v86, v107, s[36:39], s66 offen sc1
  buffer_load_dword v87, v107, s[36:39], s67 offen sc1
  s_waitcnt vmcnt(0)
  s_branch L_h2chk
L_x0retry:
  s_add_u32 s90, s90, 1
  s_cmp_gt_u32 s90, 20000
  s_cbranch_scc1 L_x0ok
  s_mov_b32 s4, m0
  s_add_u32 m0, s77, 32768
  s_xor_b32 s5, s75, 0
  buffer_load_dwordx4 v2, s[36:39], s5 offen offset:0 sc1 lds
  buffer_load_dwordx4 v2, s[36:39], s5 offen offset:1024 sc1 lds
  buffer_load_dwordx4 v2, s[36:39], s5 offen offset:2048 sc1 lds
  buffer_load_dwordx4 v2, s[36:39], s5 offen offset:3072 sc1 lds
  s_add_u32 m0, s77, 49152
  s_xor_b32 s5, s75, 32768
  buffer_load_dwordx4 v2, s[36:39], s5 offen offset:0 sc1 lds
  buffer_load_dwordx4 v2, s[36:39], s5 offen offset:1024 sc1 lds
  buffer_load_dwordx4 v2, s[36:39], s5 offen offset:2048 sc1 lds
  buffer_load_dwordx4 v2, s[36:39], s5 offen offset:3072 sc1 lds
  s_add_u32 m0, s77, 65536
  s_xor_b32 s5, s75, 65536
  buffer_load_dwordx4 v2, s[36:39], s5 offen offset:0 sc1 lds
  buffer_load_dwordx4 v2, s[36:39], s5 offen offset:1024 sc1 lds
  buffer_load_dwordx4 v2, s[36:39], s5 offen offset:2048 sc1 lds
  buffer_load_dwordx4 v2, s[36:39], s5 offen offset:3072 sc1 lds
  s_mov_b32 m0, s4
  s_waitcnt vmcnt(8)
  ds_read2st64_b32 v[48:49], v8 offset0:128 offset1:132
  ds_read2st64_b32 v[50:51], v8 offset0:136 offset1:140
  s_waitcnt lgkmcnt(0)
  v_max3_f32 v48, abs(v48), abs(v49), abs(v50)
  v_max_f32_e64 v48, v48, abs(v51)
  v_cmp_le_f32 vcc, 0x60000000, v48
  s_cbranch_vccnz L_x0retry
  s_branch L_x0ok
L_p0retry:
  s_add_u32 s90, s90, 1
  s_cmp_gt_u32 s90, 20000
  s_cbranch_scc1 L_p0ok
  s_add_u32 s79, s72, 262144
  buffer_load_dwordx4 v[128:131], v2, s[36:39], s79 offen offset:0 sc1
  buffer_load_dwordx4 v[132:135], v2, s[36:39], s79 offen offset:1024 sc1
  s_waitcnt vmcnt(0)
  v_bitop3_b32 v60, v129, v131, s48 bitop3:0x7e
  v_bitop3_b32 v61, v133, v135, s48 bitop3:0x7e
  v_bitop3_b32 v60, v60, v61, v27 bitop3:0xa8
  v_cmp_ne_u32 vcc, 0, v60
  s_cbranch_vccnz L_p0retry
  s_branch L_p0ok
L_p1retry:
  s_add_u32 s90, s90, 1
  s_cmp_gt_u32 s90, 20000
  s_cbranch_scc1 L_p1ok
  s_add_u32 s79, s72, 524288
  buffer_load_dwordx4 v[136:139], v2, s[36:39], s79 offen offset:0 sc1
  buffer_load_dwordx4 v[140:143], v2, s[36:39], s79 offen offset:1024 sc1
  s_waitcnt vmcnt(0)
  v_bitop3_b32 v60, v137, v139, s48 bitop3:0x7e
  v_bitop3_b32 v61, v141, v143, s48 bitop3:0x7e
  v_bitop3_b32 v60, v60, v61, v27 bitop3:0xa8
  v_cmp_ne_u32 vcc, 0, v60
  s_cbranch_vccnz L_p1retry
  s_branch L_p1ok
L_p2retry:
  s_add_u32 s90, s90, 1
  s_cmp_gt_u32 s90, 20000
  s_cbranch_scc1 L_p2ok
  s_xor_b32 s79, s74, 0x50000
  buffer_load_dwordx4 v[144:147], v2, s[36:39], s79 offen offset:0 sc1
  buffer_load_dwordx4 v[148:151], v2, s[36:39], s79 offen offset:1024 sc1
  s_waitcnt vmcnt(0)
  v_bitop3_b32 v60, v145, v147, s56 bitop3:0x7e
  v_bitop3_b32 v61, v149, v151, s56 bitop3:0x7e
  v_bitop3_b32 v60, v60, v61, v27 bitop3:0xa8
  v_cmp_ne_u32 vcc, 0, v60
  s_cbranch_vccnz L_p2retry
  s_branch L_p2ok
L_x1retry:
  s_add_u32 s90, s90, 1
  s_cmp_gt_u32 s90, 20000
  s_cbranch_scc1 L_x1ok
  s_mov_b32 s4, m0
  s_add_u32 m0, s77, 49152
  s_xor_b32 s5, s75, 32768
  buffer_load_dwordx4 v2, s[36:39], s5 offen offset:0 sc1 lds
  buffer_load_dwordx4 v2, s[36:39], s5 offen offset:1024 sc1 lds
  buffer_load_dwordx4 v2, s[36:39], s5 offen offset:2048 sc1 lds
  buffer_load_dwordx4 v2, s[36:39], s5 offen offset:3072 sc1 lds
  s_add_u32 m0, s77, 65536
  s_xor_b32 s5, s75, 65536
  buffer_load_dwordx4 v2, s[36:39], s5 offen offset:0 sc1 lds
  buffer_load_dwordx4 v2, s[36:39], s5 offen offset:1024 sc1 lds
  buffer_load_dwordx4 v2, s[36:39], s5 offen offset:2048 sc1 lds
  buffer_load_dwordx4 v2, s[36:39], s5 offen offset:3072 sc1 lds
  s_add_u32 m0, s77, 0
  s_nop 0
  s_xor_b32 s5, s75, 98304
  buffer_load_dwordx4 v2, s[36:39], s5 offen offset:0 sc1 lds
  buffer_load_dwordx4 v2, s[36:39], s5 offen offset:1024 sc1 lds
  buffer_load_dwordx4 v2, s[36:39], s5 offen offset:2048 sc1 lds
  buffer_load_dwordx4 v2, s[36:39], s5 offen offset:3072 sc1 lds
  s_add_u32 m0, s77, 81920
  s_xor_b32 s5, s75, 131072
  buffer_load_dwordx4 v2, s[36:39], s5 offen offset:0 sc1 lds
  buffer_load_dwordx4 v2, s[36:39], s5 offen offset:1024 sc1 lds
  buffer_load_dwordx4 v2, s[36:39], s5 offen offset:2048 sc1 lds
  buffer_load_dwordx4 v2, s[36:39], s5 offen offset:3072 sc1 lds
  s_mov_b32 m0, s4
  s_waitcnt vmcnt(12)
  ds_read2st64_b32 v[48:49], v8 offset0:192 offset1:196
  ds_read2st64_b32 v[50:51], v8 offset0:200 offset1:204
  s_waitcnt lgkmcnt(0)
  v_max3_f32 v48, abs(v48), abs(v49), abs(v50)
  v_max_f32_e64 v48, v48, abs(v51)
  v_cmp_le_f32 vcc, 0x60000000, v48
  s_cbranch_vccnz L_x1retry
  s_branch L_x1ok
L_x2retry:
  s_add_u32 s90, s90, 1
  s_cmp_gt_u32 s90, 20000
  s_cbranch_scc1 L_x2ok
  s_mov_b32 s4, m0
  s_add_u32 m0, s77, 65536
  s_xor_b32 s5, s75, 65536
  buffer_load_dwordx4 v2, s[36:39], s5 offen offset:0 sc1 lds
  buffer_load_dwordx4 v2, s[36:39], s5 offen offset:1024 sc1 lds
  buffer_load_dwordx4 v2, s[36:39], s5 offen offset:2048 sc1 lds
  buffer_load_dwordx4 v2, s[36:39], s5 offen offset:3072 sc1 lds
  s_add_u32 m0, s77, 0
  s_nop 0
  s_xor_b32 s5, s75, 98304
  buffer_load_dwordx4 v2, s[36:39], s5 offen offset:0 sc1 lds
  buffer_load_dwordx4 v2, s[36:39], s5 offen offset:1024 sc1 lds
  buffer_load_dwordx4 v2, s[36:39], s5 offen offset:2048 sc1 lds
  buffer_load_dwordx4 v2, s[36:39], s5 offen offset:3072 sc1 lds
  s_add_u32 m0, s77, 81920
  s_xor_b32 s5, s75, 131072
  buffer_load_dwordx4 v2, s[36:39], s5 offen offset:0 sc1 lds
  buffer_load_dwordx4 v2, s[36:39], s5 offen offset:1024 sc1 lds
  buffer_load_dwordx4 v2, s[36:39], s5 offen offset:2048 sc1 lds
  buffer_load_dwordx4 v2, s[36:39], s5 offen offset:3072 sc1 lds
  s_add_u32 m0, s77, 98304
  s_xor_b32 s5, s75, 163840
  buffer_load_dwordx4 v2, s[36:39], s5 offen offset:0 sc1 lds
  buffer_load_dwordx4 v2, s[36:39], s5 offen offset:1024 sc1 lds
  buffer_load_dwordx4 v2, s[36:39], s5 offen offset:2048 sc1 lds
  buffer_load_dwordx4 v2, s[36:39], s5 offen offset:3072 sc1 lds
  s_mov_b32 m0, s4
  s_waitcnt vmcnt(8)
  ds_read2st64_b32 v[48:49], v9 offset0:0 offset1:4
  ds_read2st64_b32 v[50:51], v9 offset0:8 offset1:12
  ds_read2st64_b32 v[52:53], v8 offset0:0 offset1:4
  ds_read2st64_b32 v[54:55], v8 offset0:8 offset1:12
  s_waitcnt lgkmcnt(0)
  v_max3_f32 v48, abs(v48), abs(v49), abs(v50)
  v_max3_f32 v52, abs(v52), abs(v53), abs(v54)
  v_max3_f32 v48, v48, abs(v51), abs(v55)
  v_max_f32 v48, v48, v52
  v_cmp_le_f32 vcc, 0x60000000, v48
  s_cbranch_vccnz L_x2retry
  s_branch L_x2ok
L_x4retry:
  s_add_u32 s90, s90, 1
  s_cmp_gt_u32 s90, 20000
  s_cbranch_scc1 L_x4ok
  s_mov_b32 s4, m0
  s_nop 0
  s_add_u32 m0, s77, 81920
  s_xor_b32 s5, s75, 131072
  buffer_load_dwordx4 v2, s[36:39], s5 offen offset:0 sc1 lds
  buffer_load_dwordx4 v2, s[36:39], s5 offen offset:1024 sc1 lds
  buffer_load_dwordx4 v2, s[36:39], s5 offen offset:2048 sc1 lds
  buffer_load_dwordx4 v2, s[36:39], s5 offen offset:3072 sc1 lds
  s_add_u32 m0, s77, 98304
  s_xor_b32 s5, s75, 163840
  buffer_load_dwordx4 v2, s[36:39], s5 offen offset:0 sc1 lds
  buffer_load_dwordx4 v2, s[36:39], s5 offen offset:1024 sc1 lds
  buffer_load_dwordx4 v2, s[36:39], s5 offen offset:2048 sc1 lds
  buffer_load_dwordx4 v2, s[36:39], s5 offen offset:3072 sc1 lds
  s_add_u32 m0, s77, 16384
  s_xor_b32 s5, s75, 196608
  buffer_load_dwordx4 v2, s[36:39], s5 offen offset:0 sc1 lds
  buffer_load_dwordx4 v2, s[36:39], s5 offen offset:1024 sc1 lds
  buffer_load_dwordx4 v2, s[36:39], s5 offen offset:2048 sc1 lds
  buffer_load_dwordx4 v2, s[36:39], s5 offen offset:3072 sc1 lds
  s_add_u32 m0, s77, 32768
  s_xor_b32 s5, s75, 229376
  buffer_load_dwordx4 v2, s[36:39], s5 offen offset:0 sc1 lds
  buffer_load_dwordx4 v2, s[36:39], s5 offen offset:1024 sc1 lds
  buffer_load_dwordx4 v2, s[36:39], s5 offen offset:2048 sc1 lds
  buffer_load_dwordx4 v2, s[36:39], s5 offen offset:3072 sc1 lds
  s_mov_b32 m0, s4
  s_waitcnt vmcnt(8)
  ds_read2st64_b32 v[48:49], v9 offset0:64 offset1:68
  ds_read2st64_b32 v[50:51], v9 offset0:72 offset1:76
  ds_read2st64_b32 v[52:53], v9 offset0:128 offset1:132
  ds_read2st64_b32 v[54:55], v9 offset0:136 offset1:140
  s_waitcnt lgkmcnt(0)
  v_max3_f32 v48, abs(v48), abs(v49), abs(v50)
  v_max3_f32 v52, abs(v52), abs(v53), abs(v54)
  v_max3_f32 v48, v48, abs(v51), abs(v55)
  v_max_f32 v48, v48, v52
  v_cmp_le_f32 vcc, 0x60000000, v48
  s_cbranch_vccnz L_x4retry
  s_branch L_x4ok
L_x6retry:
  s_add_u32 s90, s90, 1
  s_cmp_gt_u32 s90, 20000
  s_cbranch_scc1 L_x6ok
  s_mov_b32 s4, m0
  s_nop 0
  s_add_u32 m0, s77, 16384
  s_xor_b32 s5, s75, 196608
  buffer_load_dwordx4 v2, s[36:39], s5 offen offset:0 sc1 lds
  buffer_load_dwordx4 v2, s[36:39], s5 offen offset:1024 sc1 lds
  buffer_load_dwordx4 v2, s[36:39], s5 offen offset:2048 sc1 lds
  buffer_load_dwordx4 v2, s[36:39], s5 offen offset:3072 sc1 lds
  s_add_u32 m0, s77, 32768
  s_xor_b32 s5, s75, 229376
  buffer_load_dwordx4 v2, s[36:39], s5 offen offset:0 sc1 lds
  buffer_load_dwordx4 v2, s[36:39], s5 offen offset:1024 sc1 lds
  buffer_load_dwordx4 v2, s[36:39], s5 offen offset:2048 sc1 lds
  buffer_load_dwordx4 v2, s[36:39], s5 offen offset:3072 sc1 lds
  s_mov_b32 m0, s4
  s_waitcnt vmcnt(0)
  ds_read2st64_b32 v[48:49], v8 offset0:64 offset1:68
  ds_read2st64_b32 v[50:51], v8 offset0:72 offset1:76
  ds_read2st64_b32 v[52:53], v8 offset0:128 offset1:132
  ds_read2st64_b32 v[54:55], v8 offset0:136 offset1:140
  s_waitcnt lgkmcnt(0)
  v_max3_f32 v48, abs(v48), abs(v49), abs(v50)
  v_max3_f32 v52, abs(v52), abs(v53), abs(v54)
  v_max3_f32 v48, v48, abs(v51), abs(v55)
  v_max_f32 v48, v48, v52
  v_cmp_le_f32 vcc, 0x60000000, v48
  s_cbranch_vccnz L_x6retry
  s_branch L_x6ok
L_x8retry:
  s_add_u32 s90, s90, 1
  s_cmp_gt_u32 s90, 20000
  s_cbranch_scc1 L_x8ok
  s_mov_b32 s4, m0
  s_add_u32 m0, s71, 0
  s_xor_b32 s5, s70, 0
  s_nop 0
  buffer_load_dwordx4 v2, s[36:39], s5 offen offset:0 sc1 lds
  buffer_load_dwordx4 v2, s[36:39], s5 offen offset:1024 sc1 lds
  buffer_load_dwordx4 v2, s[36:39], s5 offen offset:2048 sc1 lds
  buffer_load_dwordx4 v2, s[36:39], s5 offen offset:3072 sc1 lds
  s_add_u32 m0, s71, 65536
  s_xor_b32 s5, s70, 32768
  buffer_load_dwordx4 v2, s[36:39], s5 offen offset:0 sc1 lds
  buffer_load_dwordx4 v2, s[36:39], s5 offen offset:1024 sc1 lds
  buffer_load_dwordx4 v2, s[36:39], s5 offen offset:2048 sc1 lds
  buffer_load_dwordx4 v2, s[36:39], s5 offen offset:3072 sc1 lds
  s_add_u32 m0, s71, 81920
  s_xor_b32 s5, s70, 262144
  buffer_load_dwordx4 v2, s[36:39], s5 offen offset:0 sc1 lds
  buffer_load_dwordx4 v2, s[36:39], s5 offen offset:1024 sc1 lds
  buffer_load_dwordx4 v2, s[36:39], s5 offen offset:2048 sc1 lds
  buffer_load_dwordx4 v2, s[36:39], s5 offen offset:3072 sc1 lds
  s_mov_b32 m0, s4
  s_waitcnt vmcnt(8)
  ds_read2st64_b64 v[44:47], v12 offset0:0 offset1:2
  ds_read2st64_b64 v[48:51], v12 offset0:4 offset1:6
  s_waitcnt lgkmcnt(0)
  v_bitop3_b32 v44, v44, v45, s48 bitop3:0x7e
  v_bitop3_b32 v46, v46, v47, s48 bitop3:0x7e
  v_bitop3_b32 v48, v48, v49, s48 bitop3:0x7e
  v_bitop3_b32 v50, v50, v51, s48 bitop3:0x7e
  v_or3_b32 v44, v44, v46, v48
  v_bitop3_b32 v44, v44, v50, v27 bitop3:0xa8
  v_cmp_ne_u32 vcc, 0, v44
  s_cbranch_vccnz L_x8retry
  s_branch L_x8ok
L_x9retry:
  s_add_u32 s90, s90, 1
  s_cmp_gt_u32 s90, 20000
  s_cbranch_scc1 L_x9ok
  s_mov_b32 s4, m0
  s_nop 0
  s_add_u32 m0, s71, 65536
  s_xor_b32 s5, s70, 32768
  buffer_load_dwordx4 v2, s[36:39], s5 offen offset:0 sc1 lds
  buffer_load_dwordx4 v2, s[36:39], s5 offen offset:1024 sc1 lds
  buffer_load_dwordx4 v2, s[36:39], s5 offen offset:2048 sc1 lds
  buffer_load_dwordx4 v2, s[36:39], s5 offen offset:3072 sc1 lds
  s_add_u32 m0, s71, 81920
  s_xor_b32 s5, s70, 262144
  buffer_load_dwordx4 v2, s[36:39], s5 offen offset:0 sc1 lds
  buffer_load_dwordx4 v2, s[36:39], s5 offen offset:1024 sc1 lds
  buffer_load_dwordx4 v2, s[36:39], s5 offen offset:2048 sc1 lds
  buffer_load_dwordx4 v2, s[36:39], s5 offen offset:3072 sc1 lds
  s_add_u32 m0, s71, 16384
  s_xor_b32 s5, s70, 294912
  buffer_load_dwordx4 v2, s[36:39], s5 offen offset:0 sc1 lds
  buffer_load_dwordx4 v2, s[36:39], s5 offen offset:1024 sc1 lds
  buffer_load_dwordx4 v2, s[36:39], s5 offen offset:2048 sc1 lds
  buffer_load_dwordx4 v2, s[36:39], s5 offen offset:3072 sc1 lds
  s_mov_b32 m0, s4
  s_waitcnt vmcnt(8)
  ds_read2st64_b64 v[44:47], v13 offset0:0 offset1:2
  ds_read2st64_b64 v[48:51], v13 offset0:4 offset1:6
  s_waitcnt lgkmcnt(0)
  v_bitop3_b32 v44, v44, v45, s48 bitop3:0x7e
  v_bitop3_b32 v46, v46, v47, s48 bitop3:0x7e
  v_bitop3_b32 v48, v48, v49, s48 bitop3:0x7e
  v_bitop3_b32 v50, v50, v51, s48 bitop3:0x7e
  v_or3_b32 v44, v44, v46, v48
  v_bitop3_b32 v44, v44, v50, v27 bitop3:0xa8
  v_cmp_ne_u32 vcc, 0, v44
  s_cbranch_vccnz L_x9retry
  s_branch L_x9ok
L_x10retry:
  s_add_u32 s90, s90, 1
  s_cmp_gt_u32 s90, 20000
  s_cbranch_scc1 L_x10ok
  s_mov_b32 s4, m0
  s_nop 0
  s_add_u32 m0, s71, 81920
  s_xor_b32 s5, s70, 262144
  buffer_load_dwordx4 v2, s[36:39], s5 offen offset:0 sc1 lds
  buffer_load_dwordx4 v2, s[36:39], s5 offen offset:1024 sc1 lds
  buffer_load_dwordx4 v2, s[36:39], s5 offen offset:2048 sc1 lds
  buffer_load_dwordx4 v2, s[36:39], s5 offen offset:3072 sc1 lds
  s_add_u32 m0, s71, 16384
  s_xor_b32 s5, s70, 294912
  buffer_load_dwordx4 v2, s[36:39], s5 offen offset:0 sc1 lds
  buffer_load_dwordx4 v2, s[36:39], s5 offen offset:1024 sc1 lds
  buffer_load_dwordx4 v2, s[36:39], s5 offen offset:2048 sc1 lds
  buffer_load_dwordx4 v2, s[36:39], s5 offen offset:3072 sc1 lds
  s_add_u32 m0, s71, 32768
  s_xor_b32 s5, s70, 524288
  buffer_load_dwordx4 v2, s[36:39], s5 offen offset:0 sc1 lds
  buffer_load_dwordx4 v2, s[36:39], s5 offen offset:1024 sc1 lds
  buffer_load_dwordx4 v2, s[36:39], s5 offen offset:2048 sc1 lds
  buffer_load_dwordx4 v2, s[36:39], s5 offen offset:3072 sc1 lds
  s_mov_b32 m0, s4
  s_waitcnt vmcnt(8)
  ds_read2st64_b64 v[44:47], v13 offset0:32 offset1:34
  ds_read2st64_b64 v[48:51], v13 offset0:36 offset1:38
  s_waitcnt lgkmcnt(0)
  v_bitop3_b32 v44, v44, v45, s48 bitop3:0x7e
  v_bitop3_b32 v46, v46, v47, s48 bitop3:0x7e
  v_bitop3_b32 v48, v48, v49, s48 bitop3:0x7e
  v_bitop3_b32 v50, v50, v51, s48 bitop3:0x7e
  v_or3_b32 v44, v44, v46, v48
  v_bitop3_b32 v44, v44, v50, v27 bitop3:0xa8
  v_cmp_ne_u32 vcc, 0, v44
  s_cbranch_vccnz L_x10retry
  s_branch L_x10ok
L_x11retry:
  s_add_u32 s90, s90, 1
  s_cmp_gt_u32 s90, 20000
  s_cbranch_scc1 L_x11ok
  s_mov_b32 s4, m0
  s_nop 0
  s_add_u32 m0, s71, 16384
  s_xor_b32 s5, s70, 294912
  buffer_load_dwordx4 v2, s[36:39], s5 offen offset:0 sc1 lds
  buffer_load_dwordx4 v2, s[36:39], s5 offen offset:1024 sc1 lds
  buffer_load_dwordx4 v2, s[36:39], s5 offen offset:2048 sc1 lds
  buffer_load_dwordx4 v2, s[36:39], s5 offen offset:3072 sc1 lds
  s_add_u32 m0, s71, 32768
  s_xor_b32 s5, s70, 524288
  buffer_load_dwordx4 v2, s[36:39], s5 offen offset:0 sc1 lds
  buffer_load_dwordx4 v2, s[36:39], s5 offen offset:1024 sc1 lds
  buffer_load_dwordx4 v2, s[36:39], s5 offen offset:2048 sc1 lds
  buffer_load_dwordx4 v2, s[36:39], s5 offen offset:3072 sc1 lds
  s_add_u32 m0, s71, 0
  s_xor_b32 s5, s70, 557056
  buffer_load_dwordx4 v2, s[36:39], s5 offen offset:0 sc1 lds
  buffer_load_dwordx4 v2, s[36:39], s5 offen offset:1024 sc1 lds
  buffer_load_dwordx4 v2, s[36:39], s5 offen offset:2048 sc1 lds
  buffer_load_dwordx4 v2, s[36:39], s5 offen offset:3072 sc1 lds
  s_mov_b32 m0, s4
  s_waitcnt vmcnt(8)
  ds_read2st64_b64 v[44:47], v12 offset0:32 offset1:34
  ds_read2st64_b64 v[48:51], v12 offset0:36 offset1:38
  s_waitcnt lgkmcnt(0)
  v_bitop3_b32 v44, v44, v45, s48 bitop3:0x7e
  v_bitop3_b32 v46, v46, v47, s48 bitop3:0x7e
  v_bitop3_b32 v48, v48, v49, s48 bitop3:0x7e
  v_bitop3_b32 v50, v50, v51, s48 bitop3:0x7e
  v_or3_b32 v44, v44, v46, v48
  v_bitop3_b32 v44, v44, v50, v27 bitop3:0xa8
  v_cmp_ne_u32 vcc, 0, v44
  s_cbranch_vccnz L_x11retry
  s_branch L_x11ok
L_x12retry:
  s_add_u32 s90, s90, 1
  s_cmp_gt_u32 s90, 20000
  s_cbranch_scc1 L_x12ok
  s_mov_b32 s4, m0
  s_add_u32 m0, s71, 32768
  s_xor_b32 s5, s70, 524288
  buffer_load_dwordx4 v2, s[36:39], s5 offen offset:0 sc1 lds
  buffer_load_dwordx4 v2, s[36:39], s5 offen offset:1024 sc1 lds
  buffer_load_dwordx4 v2, s[36:39], s5 offen offset:2048 sc1 lds
  buffer_load_dwordx4 v2, s[36:39], s5 offen offset:3072 sc1 lds
  s_add_u32 m0, s71, 0
  s_nop 0
  s_xor_b32 s5, s70, 557056
  buffer_load_dwordx4 v2, s[36:39], s5 offen offset:0 sc1 lds
  buffer_load_dwordx4 v2, s[36:39], s5 offen offset:1024 sc1 lds
  buffer_load_dwordx4 v2, s[36:39], s5 offen offset:2048 sc1 lds
  buffer_load_dwordx4 v2, s[36:39], s5 offen offset:3072 sc1 lds
  s_add_u32 m0, s71, 49152
  s_xor_b32 s5, s70, 786432
  buffer_load_dwordx4 v2, s[36:39], s5 offen offset:0 sc1 lds
  buffer_load_dwordx4 v2, s[36:39], s5 offen offset:1024 sc1 lds
  buffer_load_dwordx4 v2, s[36:39], s5 offen offset:2048 sc1 lds
  buffer_load_dwordx4 v2, s[36:39], s5 offen offset:3072 sc1 lds
  s_mov_b32 m0, s4
  s_waitcnt vmcnt(8)
  ds_read2st64_b64 v[44:47], v12 offset0:64 offset1:66
  ds_read2st64_b64 v[48:51], v12 offset0:68 offset1:70
  s_waitcnt lgkmcnt(0)
  v_bitop3_b32 v44, v44, v45, s48 bitop3:0x7e
  v_bitop3_b32 v46, v46, v47, s48 bitop3:0x7e
  v_bitop3_b32 v48, v48, v49, s48 bitop3:0x7e
  v_bitop3_b32 v50, v50, v51, s48 bitop3:0x7e
  v_or3_b32 v44, v44, v46, v48
  v_bitop3_b32 v44, v44, v50, v27 bitop3:0xa8
  v_cmp_ne_u32 vcc, 0, v44
  s_cbranch_vccnz L_x12retry
  s_branch L_x12ok
L_x13retry:
  s_add_u32 s90, s90, 1
  s_cmp_gt_u32 s90, 20000
  s_cbranch_scc1 L_x13ok
  s_mov_b32 s4, m0
  s_add_u32 m0, s71, 0
  s_xor_b32 s5, s70, 557056
  buffer_load_dwordx4 v2, s[36:39], s5 offen offset:0 sc1 lds
  buffer_load_dwordx4 v2, s[36:39], s5 offen offset:1024 sc1 lds
  buffer_load_dwordx4 v2, s[36:39], s5 offen offset:2048 sc1 lds
  buffer_load_dwordx4 v2, s[36:39], s5 offen offset:3072 sc1 lds
  s_add_u32 m0, s71, 49152
  s_xor_b32 s5, s70, 786432
  buffer_load_dwordx4 v2, s[36:39], s5 offen offset:0 sc1 lds
  buffer_load_dwordx4 v2, s[36:39], s5 offen offset:1024 sc1 lds
  buffer_load_dwordx4 v2, s[36:39], s5 offen offset:2048 sc1 lds
  buffer_load_dwordx4 v2, s[36:39], s5 offen offset:3072 sc1 lds
  s_add_u32 m0, s71, 65536
  s_xor_b32 s5, s70, 819200
  buffer_load_dwordx4 v2, s[36:39], s5 offen offset:0 sc1 lds
  buffer_load_dwordx4 v2, s[36:39], s5 offen offset:1024 sc1 lds
  buffer_load_dwordx4 v2, s[36:39], s5 offen offset:2048 sc1 lds
  buffer_load_dwordx4 v2, s[36:39], s5 offen offset:3072 sc1 lds
  s_mov_b32 m0, s4
  s_waitcnt vmcnt(8)
  ds_read2st64_b64 v[44:47], v12 offset0:0 offset1:2
  ds_read2st64_b64 v[48:51], v12 offset0:4 offset1:6
  s_waitcnt lgkmcnt(0)
  v_bitop3_b32 v44, v44, v45, s48 bitop3:0x7e
  v_bitop3_b32 v46, v46, v47, s48 bitop3:0x7e
  v_bitop3_b32 v48, v48, v49, s48 bitop3:0x7e
  v_bitop3_b32 v50, v50, v51, s48 bitop3:0x7e
  v_or3_b32 v44, v44, v46, v48
  v_bitop3_b32 v44, v44, v50, v27 bitop3:0xa8
  v_cmp_ne_u32 vcc, 0, v44
  s_cbranch_vccnz L_x13retry
  s_branch L_x13ok
L_x14retry:
  s_add_u32 s90, s90, 1
  s_cmp_gt_u32 s90, 20000
  s_cbranch_scc1 L_x14ok
  s_mov_b32 s4, m0
  s_nop 0
  s_add_u32 m0, s71, 49152
  s_xor_b32 s5, s70, 786432
  buffer_load_dwordx4 v2, s[36:39], s5 offen offset:0 sc1 lds
  buffer_load_dwordx4 v2, s[36:39], s5 offen offset:1024 sc1 lds
  buffer_load_dwordx4 v2, s[36:39], s5 offen offset:2048 sc1 lds
  buffer_load_dwordx4 v2, s[36:39], s5 offen offset:3072 sc1 lds
  s_add_u32 m0, s71, 65536
  s_xor_b32 s5, s70, 819200
  buffer_load_dwordx4 v2, s[36:39], s5 offen offset:0 sc1 lds
  buffer_load_dwordx4 v2, s[36:39], s5 offen offset:1024 sc1 lds
  buffer_load_dwordx4 v2, s[36:39], s5 offen offset:2048 sc1 lds
  buffer_load_dwordx4 v2, s[36:39], s5 offen offset:3072 sc1 lds
  s_mov_b32 m0, s4
  s_waitcnt vmcnt(4)
  ds_read2st64_b64 v[44:47], v12 offset0:96 offset1:98
  ds_read2st64_b64 v[48:51], v12 offset0:100 offset1:102
  s_waitcnt lgkmcnt(0)
  v_bitop3_b32 v44, v44, v45, s48 bitop3:0x7e
  v_bitop3_b32 v46, v46, v47, s48 bitop3:0x7e
  v_bitop3_b32 v48, v48, v49, s48 bitop3:0x7e
  v_bitop3_b32 v50, v50, v51, s48 bitop3:0x7e
  v_or3_b32 v44, v44, v46, v48
  v_bitop3_b32 v44, v44, v50, v27 bitop3:0xa8
  v_cmp_ne_u32 vcc, 0, v44
  s_cbranch_vccnz L_x14retry
  s_branch L_x14ok
L_x15retry:
  s_add_u32 s90, s90, 1
  s_cmp_gt_u32 s90, 20000
  s_cbranch_scc1 L_x15ok
  s_mov_b32 s4, m0
  s_add_u32 m0, s71, 65536
  s_xor_b32 s5, s70, 819200
  buffer_load_dwordx4 v2, s[36:39], s5 offen offset:0 sc1 lds
  buffer_load_dwordx4 v2, s[36:39], s5 offen offset:1024 sc1 lds
  buffer_load_dwordx4 v2, s[36:39], s5 offen offset:2048 sc1 lds
  buffer_load_dwordx4 v2, s[36:39], s5 offen offset:3072 sc1 lds
  s_mov_b32 m0, s4
  s_waitcnt vmcnt(0)
  ds_read2st64_b64 v[44:47], v13 offset0:0 offset1:2
  ds_read2st64_b64 v[48:51], v13 offset0:4 offset1:6
  s_waitcnt lgkmcnt(0)
  v_bitop3_b32 v44, v44, v45, s48 bitop3:0x7e
  v_bitop3_b32 v46, v46, v47, s48 bitop3:0x7e
  v_bitop3_b32 v48, v48, v49, s48 bitop3:0x7e
  v_bitop3_b32 v50, v50, v51, s48 bitop3:0x7e
  v_or3_b32 v44, v44, v46, v48
  v_bitop3_b32 v44, v44, v50, v27 bitop3:0xa8
  v_cmp_ne_u32 vcc, 0, v44
  s_cbranch_vccnz L_x15retry
  s_branch L_x15ok
L_end:
  s_endpgm
.section .rodata,"a"
.p2align 6
.amdhsa_kernel sequential_preLN__ssm_conv_s4d__mixer_channel_mlp__prompt_kernel
  .amdhsa_next_free_vgpr 512
  .amdhsa_next_free_sgpr 102
  .amdhsa_accum_offset 256
  .amdhsa_group_segment_fixed_size 0
  .amdhsa_kernarg_size 120
  .amdhsa_user_sgpr_count 2
  .amdhsa_user_sgpr_kernarg_segment_ptr 1
  .amdhsa_system_sgpr_workgroup_id_x 1
.end_amdhsa_kernel
```
